```python
import torch

def _softmax(x, axis=-1):
    return torch.softmax(x, dim=axis)
def _gelu(x):
    return torch.nn.functional.gelu(x, approximate="tanh")
def _silu(x):
    return torch.nn.functional.silu(x)
def _sigmoid(x):
    return torch.sigmoid(x)
def _layernorm(x, axis=-1, eps=1e-5):
    m = x.mean(dim=axis, keepdim=True)
    v = x.var(dim=axis, keepdim=True, unbiased=False)
    return (x - m) / torch.sqrt(v + eps)
def _scatter_add(tgt, idx, src, axis=0):
    return tgt.clone().index_add_(axis, idx, src)
def _segment_sum(src, seg, n):
    out = torch.zeros((n,) + src.shape[1:], dtype=src.dtype)
    return out.index_add_(0, seg, src)
def _pad(x, pw):
    flat = tuple(v for pair in reversed(pw) for v in pair)
    return torch.nn.functional.pad(x, flat)

kernel_name = 'standalone__deep_cross_wide_deep__recsys'

def setup_inputs():

    _w = (lambda a: (lambda t: t.to(torch.bfloat16) if t.is_floating_point() else t)(torch.as_tensor(a)))
    B, F, D = 16384, 26, 128
    V, Nd = min(1000000, 100000), 13
    Din = F * D
    H = 4 * D
    return {
        "idx": _w((lambda lo, hi, *s: torch.randint(lo, hi, s))(0, V, B, F).to(torch.int64)),
        "table": _w((lambda *s: torch.randn(*s, dtype=torch.bfloat16) * 1.6)(V, D) * 0.05),
        "x_wide": _w((lambda *s: torch.randn(*s, dtype=torch.bfloat16) * 1.6)(B, Nd)),
        "w_wide": _w((lambda *s: torch.randn(*s, dtype=torch.bfloat16) * 1.6)(Nd) * 0.05),
        "b_wide": _w((lambda *s: torch.randn(*s, dtype=torch.bfloat16) * 1.6)(1) * 0.01),
        "W1": _w((lambda *s: torch.randn(*s, dtype=torch.bfloat16) * 1.6)(Din, H) * (2.0 / Din) ** 0.5),
        "b1": _w((lambda *s: torch.randn(*s, dtype=torch.bfloat16) * 1.6)(H) * 0.01),
        "W2": _w((lambda *s: torch.randn(*s, dtype=torch.bfloat16) * 1.6)(H) * (1.0 / H) ** 0.5),
        "b2": _w((lambda *s: torch.randn(*s, dtype=torch.bfloat16) * 1.6)(1) * 0.01),
    }

def reference(idx, table, x_wide, w_wide, b_wide, W1, b1, W2, b2):
    emb = table[idx]
    deep_in = emb.reshape(emb.shape[0], -1)
    h = deep_in @ W1 + b1
    h = h * (lambda x, dt: x.to(dt))(h > 0, h.dtype)
    deep_logit = h @ W2 + b2
    wide_logit = x_wide @ w_wide + b_wide
    return _sigmoid(wide_logit + deep_logit)
```

```asm
; @launch grid=(256,1,1) block=(512,1,1) lds=155648
.amdgcn_target "amdgcn-amd-amdhsa--gfx950"
.text
.globl standalone__deep_cross_wide_deep__recsys_kernel
.p2align 8
.type standalone__deep_cross_wide_deep__recsys_kernel,@function
standalone__deep_cross_wide_deep__recsys_kernel:
    s_cmp_ge_u32 s2, 256
    s_cbranch_scc1 L_end
    s_load_dwordx16 s[4:19], s[0:1], 0
    s_load_dwordx8 s[20:27], s[0:1], 64
    v_lshrrev_b32 v1, 6, v0
    v_and_b32 v0, 63, v0
    s_and_b32 s55, s2, 7
    v_readfirstlane_b32 s3, v1
    s_lshr_b32 s56, s2, 3
    s_and_b32 s48, s56, 1
    s_lshr_b32 s61, s56, 1
    s_lshl_b32 s56, s61, 3
    s_add_u32 s49, s56, s55
    s_lshl_b32 s50, s49, 7
    s_mov_b32 s51, 0
    s_getpc_b64 s[44:45]
L_pc:
    s_sub_u32 s44, s44, L_pc-standalone__deep_cross_wide_deep__recsys_kernel
    s_subb_u32 s45, s45, 0
    s_and_b32 s45, s45, 0xffff
    s_mov_b32 s46, L_text_end-standalone__deep_cross_wide_deep__recsys_kernel
    s_mov_b32 s47, 0x00020000
    s_lshr_b32 s56, s2, 3
    s_lshl_b32 s56, s56, 3
    s_add_u32 s56, s56, s3
    s_mul_i32 s57, s56, 4370
    s_lshr_b32 s57, s57, 16
    s_mul_i32 s57, s57, 15
    s_sub_u32 s56, s56, s57
    s_lshl_b32 s56, s56, 10
    v_lshlrev_b32 v33, 4, v0
    s_cmp_ge_u32 s3, 4
    s_cbranch_scc1 L_loader
    buffer_load_dwordx4 v[8:11], v33, s[44:47], s56 offen
    v_and_b32 v14, 15, v0
    v_lshrrev_b32 v15, 4, v0
    v_lshrrev_b32 v16, 1, v14
    v_xor_b32 v16, v15, v16
    v_lshlrev_b32 v16, 4, v16
    v_lshl_add_u32 v2, v14, 7, v16
    v_xor_b32 v3, 64, v2
    v_lshrrev_b32 v18, 2, v14
    v_and_b32 v19, 3, v14
    v_lshl_add_u32 v20, v15, 3, v18
    v_lshlrev_b32 v20, 9, v20
    v_lshrrev_b32 v21, 1, v19
    s_lshl_b32 s55, s3, 3
    v_add_u32 v21, s55, v21
    v_and_b32 v22, 1, v15
    v_lshlrev_b32 v22, 3, v22
    v_lshl_add_u32 v22, v18, 1, v22
    v_xor_b32 v21, v21, v22
    v_and_b32 v23, 1, v19
    v_lshlrev_b32 v23, 3, v23
    v_add_u32 v20, v20, v23
    v_add_u32 v20, 16384, v20
    v_lshl_add_u32 v4, v21, 4, v20
    v_xor_b32 v5, 32, v4
    v_xor_b32 v6, 64, v4
    v_xor_b32 v7, 96, v4
    v_mov_b32 v128, 0
    v_mov_b32 v129, 0
    v_mov_b32 v130, 0
    v_mov_b32 v131, 0
    v_mov_b32 v132, 0
    v_mov_b32 v133, 0
    v_mov_b32 v134, 0
    v_mov_b32 v135, 0
    v_mov_b32 v136, 0
    v_mov_b32 v137, 0
    v_mov_b32 v138, 0
    v_mov_b32 v139, 0
    v_mov_b32 v140, 0
    v_mov_b32 v141, 0
    v_mov_b32 v142, 0
    v_mov_b32 v143, 0
    v_mov_b32 v144, 0
    v_mov_b32 v145, 0
    v_mov_b32 v146, 0
    v_mov_b32 v147, 0
    v_mov_b32 v148, 0
    v_mov_b32 v149, 0
    v_mov_b32 v150, 0
    v_mov_b32 v151, 0
    v_mov_b32 v152, 0
    v_mov_b32 v153, 0
    v_mov_b32 v154, 0
    v_mov_b32 v155, 0
    v_mov_b32 v156, 0
    v_mov_b32 v157, 0
    v_mov_b32 v158, 0
    v_mov_b32 v159, 0
    v_mov_b32 v160, 0
    v_mov_b32 v161, 0
    v_mov_b32 v162, 0
    v_mov_b32 v163, 0
    v_mov_b32 v164, 0
    v_mov_b32 v165, 0
    v_mov_b32 v166, 0
    v_mov_b32 v167, 0
    v_mov_b32 v168, 0
    v_mov_b32 v169, 0
    v_mov_b32 v170, 0
    v_mov_b32 v171, 0
    v_mov_b32 v172, 0
    v_mov_b32 v173, 0
    v_mov_b32 v174, 0
    v_mov_b32 v175, 0
    v_mov_b32 v176, 0
    v_mov_b32 v177, 0
    v_mov_b32 v178, 0
    v_mov_b32 v179, 0
    v_mov_b32 v180, 0
    v_mov_b32 v181, 0
    v_mov_b32 v182, 0
    v_mov_b32 v183, 0
    v_mov_b32 v184, 0
    v_mov_b32 v185, 0
    v_mov_b32 v186, 0
    v_mov_b32 v187, 0
    v_mov_b32 v188, 0
    v_mov_b32 v189, 0
    v_mov_b32 v190, 0
    v_mov_b32 v191, 0
    v_mov_b32 v192, 0
    v_mov_b32 v193, 0
    v_mov_b32 v194, 0
    v_mov_b32 v195, 0
    v_mov_b32 v196, 0
    v_mov_b32 v197, 0
    v_mov_b32 v198, 0
    v_mov_b32 v199, 0
    v_mov_b32 v200, 0
    v_mov_b32 v201, 0
    v_mov_b32 v202, 0
    v_mov_b32 v203, 0
    v_mov_b32 v204, 0
    v_mov_b32 v205, 0
    v_mov_b32 v206, 0
    v_mov_b32 v207, 0
    v_mov_b32 v208, 0
    v_mov_b32 v209, 0
    v_mov_b32 v210, 0
    v_mov_b32 v211, 0
    v_mov_b32 v212, 0
    v_mov_b32 v213, 0
    v_mov_b32 v214, 0
    v_mov_b32 v215, 0
    v_mov_b32 v216, 0
    v_mov_b32 v217, 0
    v_mov_b32 v218, 0
    v_mov_b32 v219, 0
    v_mov_b32 v220, 0
    v_mov_b32 v221, 0
    v_mov_b32 v222, 0
    v_mov_b32 v223, 0
    v_mov_b32 v224, 0
    v_mov_b32 v225, 0
    v_mov_b32 v226, 0
    v_mov_b32 v227, 0
    v_mov_b32 v228, 0
    v_mov_b32 v229, 0
    v_mov_b32 v230, 0
    v_mov_b32 v231, 0
    v_mov_b32 v232, 0
    v_mov_b32 v233, 0
    v_mov_b32 v234, 0
    v_mov_b32 v235, 0
    v_mov_b32 v236, 0
    v_mov_b32 v237, 0
    v_mov_b32 v238, 0
    v_mov_b32 v239, 0
    v_mov_b32 v240, 0
    v_mov_b32 v241, 0
    v_mov_b32 v242, 0
    v_mov_b32 v243, 0
    v_mov_b32 v244, 0
    v_mov_b32 v245, 0
    v_mov_b32 v246, 0
    v_mov_b32 v247, 0
    v_mov_b32 v248, 0
    v_mov_b32 v249, 0
    v_mov_b32 v250, 0
    v_mov_b32 v251, 0
    v_mov_b32 v252, 0
    v_mov_b32 v253, 0
    v_mov_b32 v254, 0
    v_mov_b32 v255, 0
    s_waitcnt lgkmcnt(0)
    s_mov_b32 s40, s16
    s_and_b32 s41, s17, 0xffff
    s_mov_b32 s42, 1024
    s_mov_b32 s43, 0x00020000
    s_mov_b32 s44, s18
    s_and_b32 s45, s19, 0xffff
    s_mov_b32 s46, 1024
    s_mov_b32 s47, 0x00020000
    s_lshl_b32 s55, s48, 9
    s_lshl_b32 s56, s3, 7
    s_add_u32 s55, s55, s56
    v_lshlrev_b32 v14, 3, v15
    v_add_u32 v14, s55, v14
    buffer_load_dwordx2 v[120:121], v14, s[44:47], 0 offen offset:0
    buffer_load_dwordx2 v[122:123], v14, s[44:47], 0 offen offset:32
    buffer_load_dwordx2 v[124:125], v14, s[44:47], 0 offen offset:64
    buffer_load_dwordx2 v[126:127], v14, s[44:47], 0 offen offset:96
    buffer_load_dwordx2 v[112:113], v14, s[40:43], 0 offen offset:0
    buffer_load_dwordx2 v[114:115], v14, s[40:43], 0 offen offset:32
    buffer_load_dwordx2 v[116:117], v14, s[40:43], 0 offen offset:64
    buffer_load_dwordx2 v[118:119], v14, s[40:43], 0 offen offset:96
    s_cmp_ge_u32 s2, 128
    s_cbranch_scc1 L_nopre1
    s_mov_b32 s36, s14
    s_and_b32 s37, s15, 0xffff
    s_mov_b32 s38, 3407872
    s_mov_b32 s39, 0x00020000
    v_lshlrev_b32 v15, 4, v0
    s_mul_i32 s56, s2, 13312
    s_mul_i32 s57, s3, 3328
    s_add_u32 s56, s56, s57
    buffer_load_dwordx4 v[8:11], v15, s[36:39], s56 offen
    s_add_u32 s56, s56, 1024
    buffer_load_dwordx4 v[8:11], v15, s[36:39], s56 offen
    s_add_u32 s56, s56, 1024
    buffer_load_dwordx4 v[8:11], v15, s[36:39], s56 offen
    s_add_u32 s56, s56, 1024
    buffer_load_dwordx4 v[8:11], v15, s[36:39], s56 offen
    s_add_u32 s56, s56, 1024
L_nopre1:
    s_barrier
    s_cmp_lt_u32 s2, 128
    s_cbranch_scc1 L_nopre2
    s_mov_b32 s36, s14
    s_and_b32 s37, s15, 0xffff
    s_mov_b32 s38, 3407872
    s_mov_b32 s39, 0x00020000
    v_lshlrev_b32 v15, 4, v0
    s_mul_i32 s56, s2, 13312
    s_mul_i32 s57, s3, 3328
    s_add_u32 s56, s56, s57
    buffer_load_dwordx4 v[8:11], v15, s[36:39], s56 offen
    s_add_u32 s56, s56, 1024
    buffer_load_dwordx4 v[8:11], v15, s[36:39], s56 offen
    s_add_u32 s56, s56, 1024
    buffer_load_dwordx4 v[8:11], v15, s[36:39], s56 offen
    s_add_u32 s56, s56, 1024
    buffer_load_dwordx4 v[8:11], v15, s[36:39], s56 offen
    s_add_u32 s56, s56, 1024
L_nopre2:
    s_mov_b32 s65, 4294868992
    s_mov_b32 s66, 49152
    ds_read_b64_tr_b16 v[16:17], v4 offset:0
    ds_read_b128 v[80:83], v2 offset:0
    ds_read_b128 v[84:87], v3 offset:0
    ds_read_b64_tr_b16 v[18:19], v4 offset:2048
    ds_read_b64_tr_b16 v[32:33], v4 offset:16384
    ds_read_b64_tr_b16 v[34:35], v4 offset:18432
    ds_read_b64_tr_b16 v[36:37], v5 offset:16384
    ds_read_b64_tr_b16 v[38:39], v5 offset:18432
    ds_read_b64_tr_b16 v[20:21], v5 offset:0
    ds_read_b128 v[88:91], v2 offset:2048
    ds_read_b128 v[92:95], v3 offset:2048
    ds_read_b64_tr_b16 v[22:23], v5 offset:2048
    ds_read_b64_tr_b16 v[24:25], v6 offset:0
    ds_read_b64_tr_b16 v[26:27], v6 offset:2048
    ds_read_b64_tr_b16 v[40:41], v6 offset:16384
    ds_read_b64_tr_b16 v[42:43], v6 offset:18432
    ds_read_b64_tr_b16 v[44:45], v7 offset:16384
    ds_read_b128 v[96:99], v2 offset:4096
    ds_read_b128 v[100:103], v3 offset:4096
    ds_read_b64_tr_b16 v[46:47], v7 offset:18432
    ds_read_b64_tr_b16 v[28:29], v7 offset:0
    ds_read_b64_tr_b16 v[30:31], v7 offset:2048
    ds_read_b128 v[104:107], v2 offset:6144
    ds_read_b128 v[108:111], v3 offset:6144
    s_mov_b32 s52, 25
    .p2align 6
L_c_loop:
    s_waitcnt lgkmcnt(2)
    v_mfma_f32_16x16x32_bf16 v[128:131], v[16:19], v[80:83], v[128:131]
    v_mfma_f32_16x16x32_bf16 v[128:131], v[32:35], v[84:87], v[128:131]
    v_mfma_f32_16x16x32_bf16 v[132:135], v[36:39], v[84:87], v[132:135]
    v_mfma_f32_16x16x32_bf16 v[132:135], v[20:23], v[80:83], v[132:135]
    v_mfma_f32_16x16x32_bf16 v[136:139], v[24:27], v[80:83], v[136:139]
    v_mfma_f32_16x16x32_bf16 v[136:139], v[40:43], v[84:87], v[136:139]
    v_mfma_f32_16x16x32_bf16 v[140:143], v[44:47], v[84:87], v[140:143]
    v_mfma_f32_16x16x32_bf16 v[140:143], v[28:31], v[80:83], v[140:143]
    v_mfma_f32_16x16x32_bf16 v[156:159], v[28:31], v[88:91], v[156:159]
    ds_read_b128 v[80:83], v2 offset:8192
    v_mfma_f32_16x16x32_bf16 v[156:159], v[44:47], v[92:95], v[156:159]
    ds_read_b128 v[84:87], v3 offset:8192
    v_mfma_f32_16x16x32_bf16 v[152:155], v[40:43], v[92:95], v[152:155]
    s_add_u32 s51, s51, 49152
    v_mfma_f32_16x16x32_bf16 v[152:155], v[24:27], v[88:91], v[152:155]
    s_cmp_eq_u32 s51, 147456
    v_mfma_f32_16x16x32_bf16 v[148:151], v[20:23], v[88:91], v[148:151]
    s_cselect_b32 s64, s65, s66
    v_mfma_f32_16x16x32_bf16 v[148:151], v[36:39], v[92:95], v[148:151]
    s_cselect_b32 s51, 0, s51
    v_mfma_f32_16x16x32_bf16 v[144:147], v[32:35], v[92:95], v[144:147]
    v_add_u32 v4, s64, v4
    v_mfma_f32_16x16x32_bf16 v[144:147], v[16:19], v[88:91], v[144:147]
    v_add_u32 v5, s64, v5
    v_mfma_f32_16x16x32_bf16 v[160:163], v[16:19], v[96:99], v[160:163]
    ds_read_b128 v[88:91], v2 offset:10240
    v_mfma_f32_16x16x32_bf16 v[160:163], v[32:35], v[100:103], v[160:163]
    ds_read_b128 v[92:95], v3 offset:10240
    v_mfma_f32_16x16x32_bf16 v[164:167], v[36:39], v[100:103], v[164:167]
    v_add_u32 v6, s64, v6
    v_mfma_f32_16x16x32_bf16 v[164:167], v[20:23], v[96:99], v[164:167]
    v_add_u32 v7, s64, v7
    v_mfma_f32_16x16x32_bf16 v[168:171], v[24:27], v[96:99], v[168:171]
    v_mfma_f32_16x16x32_bf16 v[168:171], v[40:43], v[100:103], v[168:171]
    v_mfma_f32_16x16x32_bf16 v[172:175], v[44:47], v[100:103], v[172:175]
    v_mfma_f32_16x16x32_bf16 v[172:175], v[28:31], v[96:99], v[172:175]
    s_waitcnt lgkmcnt(4)
    v_mfma_f32_16x16x32_bf16 v[188:191], v[28:31], v[104:107], v[188:191]
    ds_read_b128 v[96:99], v2 offset:12288
    v_mfma_f32_16x16x32_bf16 v[188:191], v[44:47], v[108:111], v[188:191]
    ds_read_b128 v[100:103], v3 offset:12288
    v_mfma_f32_16x16x32_bf16 v[184:187], v[40:43], v[108:111], v[184:187]
    v_mfma_f32_16x16x32_bf16 v[184:187], v[24:27], v[104:107], v[184:187]
    v_mfma_f32_16x16x32_bf16 v[180:183], v[20:23], v[104:107], v[180:183]
    v_mfma_f32_16x16x32_bf16 v[180:183], v[36:39], v[108:111], v[180:183]
    v_mfma_f32_16x16x32_bf16 v[176:179], v[32:35], v[108:111], v[176:179]
    v_mfma_f32_16x16x32_bf16 v[176:179], v[16:19], v[104:107], v[176:179]
    s_waitcnt lgkmcnt(4)
    v_mfma_f32_16x16x32_bf16 v[192:195], v[16:19], v[80:83], v[192:195]
    ds_read_b128 v[104:107], v2 offset:14336
    v_mfma_f32_16x16x32_bf16 v[192:195], v[32:35], v[84:87], v[192:195]
    ds_read_b128 v[108:111], v3 offset:14336
    v_mfma_f32_16x16x32_bf16 v[196:199], v[36:39], v[84:87], v[196:199]
    v_add_u32 v2, s64, v2
    v_mfma_f32_16x16x32_bf16 v[196:199], v[20:23], v[80:83], v[196:199]
    v_add_u32 v3, s64, v3
    v_mfma_f32_16x16x32_bf16 v[200:203], v[24:27], v[80:83], v[200:203]
    v_mfma_f32_16x16x32_bf16 v[200:203], v[40:43], v[84:87], v[200:203]
    v_mfma_f32_16x16x32_bf16 v[204:207], v[44:47], v[84:87], v[204:207]
    s_waitcnt lgkmcnt(0)
    s_barrier
    v_mfma_f32_16x16x32_bf16 v[204:207], v[28:31], v[80:83], v[204:207]
    ds_read_b64_tr_b16 v[48:49], v4 offset:0
    v_mfma_f32_16x16x32_bf16 v[220:223], v[28:31], v[88:91], v[220:223]
    ds_read_b128 v[80:83], v2 offset:0
    v_mfma_f32_16x16x32_bf16 v[220:223], v[44:47], v[92:95], v[220:223]
    ds_read_b128 v[84:87], v3 offset:0
    v_mfma_f32_16x16x32_bf16 v[216:219], v[40:43], v[92:95], v[216:219]
    ds_read_b64_tr_b16 v[50:51], v4 offset:2048
    v_mfma_f32_16x16x32_bf16 v[216:219], v[24:27], v[88:91], v[216:219]
    ds_read_b64_tr_b16 v[64:65], v4 offset:16384
    v_mfma_f32_16x16x32_bf16 v[212:215], v[20:23], v[88:91], v[212:215]
    ds_read_b64_tr_b16 v[66:67], v4 offset:18432
    v_mfma_f32_16x16x32_bf16 v[212:215], v[36:39], v[92:95], v[212:215]
    ds_read_b64_tr_b16 v[68:69], v5 offset:16384
    v_mfma_f32_16x16x32_bf16 v[208:211], v[32:35], v[92:95], v[208:211]
    ds_read_b64_tr_b16 v[70:71], v5 offset:18432
    v_mfma_f32_16x16x32_bf16 v[208:211], v[16:19], v[88:91], v[208:211]
    ds_read_b64_tr_b16 v[52:53], v5 offset:0
    v_mfma_f32_16x16x32_bf16 v[224:227], v[16:19], v[96:99], v[224:227]
    ds_read_b128 v[88:91], v2 offset:2048
    v_mfma_f32_16x16x32_bf16 v[224:227], v[32:35], v[100:103], v[224:227]
    ds_read_b128 v[92:95], v3 offset:2048
    v_mfma_f32_16x16x32_bf16 v[228:231], v[36:39], v[100:103], v[228:231]
    ds_read_b64_tr_b16 v[54:55], v5 offset:2048
    v_mfma_f32_16x16x32_bf16 v[228:231], v[20:23], v[96:99], v[228:231]
    ds_read_b64_tr_b16 v[56:57], v6 offset:0
    v_mfma_f32_16x16x32_bf16 v[232:235], v[24:27], v[96:99], v[232:235]
    ds_read_b64_tr_b16 v[58:59], v6 offset:2048
    v_mfma_f32_16x16x32_bf16 v[232:235], v[40:43], v[100:103], v[232:235]
    ds_read_b64_tr_b16 v[72:73], v6 offset:16384
    v_mfma_f32_16x16x32_bf16 v[236:239], v[44:47], v[100:103], v[236:239]
    ds_read_b64_tr_b16 v[74:75], v6 offset:18432
    v_mfma_f32_16x16x32_bf16 v[236:239], v[28:31], v[96:99], v[236:239]
    ds_read_b64_tr_b16 v[76:77], v7 offset:16384
    v_mfma_f32_16x16x32_bf16 v[252:255], v[28:31], v[104:107], v[252:255]
    ds_read_b128 v[96:99], v2 offset:4096
    v_mfma_f32_16x16x32_bf16 v[252:255], v[44:47], v[108:111], v[252:255]
    ds_read_b128 v[100:103], v3 offset:4096
    v_mfma_f32_16x16x32_bf16 v[248:251], v[40:43], v[108:111], v[248:251]
    ds_read_b64_tr_b16 v[78:79], v7 offset:18432
    v_mfma_f32_16x16x32_bf16 v[248:251], v[24:27], v[104:107], v[248:251]
    ds_read_b64_tr_b16 v[60:61], v7 offset:0
    v_mfma_f32_16x16x32_bf16 v[244:247], v[20:23], v[104:107], v[244:247]
    ds_read_b64_tr_b16 v[62:63], v7 offset:2048
    v_mfma_f32_16x16x32_bf16 v[244:247], v[36:39], v[108:111], v[244:247]
    v_mfma_f32_16x16x32_bf16 v[240:243], v[32:35], v[108:111], v[240:243]
    v_mfma_f32_16x16x32_bf16 v[240:243], v[16:19], v[104:107], v[240:243]
    ds_read_b128 v[104:107], v2 offset:6144
    ds_read_b128 v[108:111], v3 offset:6144
    s_waitcnt lgkmcnt(2)
    v_mfma_f32_16x16x32_bf16 v[128:131], v[48:51], v[80:83], v[128:131]
    v_mfma_f32_16x16x32_bf16 v[128:131], v[64:67], v[84:87], v[128:131]
    v_mfma_f32_16x16x32_bf16 v[132:135], v[68:71], v[84:87], v[132:135]
    v_mfma_f32_16x16x32_bf16 v[132:135], v[52:55], v[80:83], v[132:135]
    v_mfma_f32_16x16x32_bf16 v[136:139], v[56:59], v[80:83], v[136:139]
    v_mfma_f32_16x16x32_bf16 v[136:139], v[72:75], v[84:87], v[136:139]
    v_mfma_f32_16x16x32_bf16 v[140:143], v[76:79], v[84:87], v[140:143]
    v_mfma_f32_16x16x32_bf16 v[140:143], v[60:63], v[80:83], v[140:143]
    v_mfma_f32_16x16x32_bf16 v[156:159], v[60:63], v[88:91], v[156:159]
    ds_read_b128 v[80:83], v2 offset:8192
    v_mfma_f32_16x16x32_bf16 v[156:159], v[76:79], v[92:95], v[156:159]
    ds_read_b128 v[84:87], v3 offset:8192
    v_mfma_f32_16x16x32_bf16 v[152:155], v[72:75], v[92:95], v[152:155]
    s_add_u32 s51, s51, 49152
    v_mfma_f32_16x16x32_bf16 v[152:155], v[56:59], v[88:91], v[152:155]
    s_cmp_eq_u32 s51, 147456
    v_mfma_f32_16x16x32_bf16 v[148:151], v[52:55], v[88:91], v[148:151]
    s_cselect_b32 s64, s65, s66
    v_mfma_f32_16x16x32_bf16 v[148:151], v[68:71], v[92:95], v[148:151]
    s_cselect_b32 s51, 0, s51
    v_mfma_f32_16x16x32_bf16 v[144:147], v[64:67], v[92:95], v[144:147]
    v_add_u32 v4, s64, v4
    v_mfma_f32_16x16x32_bf16 v[144:147], v[48:51], v[88:91], v[144:147]
    v_add_u32 v5, s64, v5
    v_mfma_f32_16x16x32_bf16 v[160:163], v[48:51], v[96:99], v[160:163]
    ds_read_b128 v[88:91], v2 offset:10240
    v_mfma_f32_16x16x32_bf16 v[160:163], v[64:67], v[100:103], v[160:163]
    ds_read_b128 v[92:95], v3 offset:10240
    v_mfma_f32_16x16x32_bf16 v[164:167], v[68:71], v[100:103], v[164:167]
    v_add_u32 v6, s64, v6
    v_mfma_f32_16x16x32_bf16 v[164:167], v[52:55], v[96:99], v[164:167]
    v_add_u32 v7, s64, v7
    v_mfma_f32_16x16x32_bf16 v[168:171], v[56:59], v[96:99], v[168:171]
    v_mfma_f32_16x16x32_bf16 v[168:171], v[72:75], v[100:103], v[168:171]
    v_mfma_f32_16x16x32_bf16 v[172:175], v[76:79], v[100:103], v[172:175]
    v_mfma_f32_16x16x32_bf16 v[172:175], v[60:63], v[96:99], v[172:175]
    s_waitcnt lgkmcnt(4)
    v_mfma_f32_16x16x32_bf16 v[188:191], v[60:63], v[104:107], v[188:191]
    ds_read_b128 v[96:99], v2 offset:12288
    v_mfma_f32_16x16x32_bf16 v[188:191], v[76:79], v[108:111], v[188:191]
    ds_read_b128 v[100:103], v3 offset:12288
    v_mfma_f32_16x16x32_bf16 v[184:187], v[72:75], v[108:111], v[184:187]
    v_mfma_f32_16x16x32_bf16 v[184:187], v[56:59], v[104:107], v[184:187]
    v_mfma_f32_16x16x32_bf16 v[180:183], v[52:55], v[104:107], v[180:183]
    v_mfma_f32_16x16x32_bf16 v[180:183], v[68:71], v[108:111], v[180:183]
    v_mfma_f32_16x16x32_bf16 v[176:179], v[64:67], v[108:111], v[176:179]
    v_mfma_f32_16x16x32_bf16 v[176:179], v[48:51], v[104:107], v[176:179]
    s_waitcnt lgkmcnt(4)
    v_mfma_f32_16x16x32_bf16 v[192:195], v[48:51], v[80:83], v[192:195]
    ds_read_b128 v[104:107], v2 offset:14336
    v_mfma_f32_16x16x32_bf16 v[192:195], v[64:67], v[84:87], v[192:195]
    ds_read_b128 v[108:111], v3 offset:14336
    v_mfma_f32_16x16x32_bf16 v[196:199], v[68:71], v[84:87], v[196:199]
    v_add_u32 v2, s64, v2
    v_mfma_f32_16x16x32_bf16 v[196:199], v[52:55], v[80:83], v[196:199]
    v_add_u32 v3, s64, v3
    v_mfma_f32_16x16x32_bf16 v[200:203], v[56:59], v[80:83], v[200:203]
    v_mfma_f32_16x16x32_bf16 v[200:203], v[72:75], v[84:87], v[200:203]
    v_mfma_f32_16x16x32_bf16 v[204:207], v[76:79], v[84:87], v[204:207]
    s_waitcnt lgkmcnt(0)
    s_barrier
    v_mfma_f32_16x16x32_bf16 v[204:207], v[60:63], v[80:83], v[204:207]
    ds_read_b64_tr_b16 v[16:17], v4 offset:0
    v_mfma_f32_16x16x32_bf16 v[220:223], v[60:63], v[88:91], v[220:223]
    ds_read_b128 v[80:83], v2 offset:0
    v_mfma_f32_16x16x32_bf16 v[220:223], v[76:79], v[92:95], v[220:223]
    ds_read_b128 v[84:87], v3 offset:0
    v_mfma_f32_16x16x32_bf16 v[216:219], v[72:75], v[92:95], v[216:219]
    ds_read_b64_tr_b16 v[18:19], v4 offset:2048
    v_mfma_f32_16x16x32_bf16 v[216:219], v[56:59], v[88:91], v[216:219]
    ds_read_b64_tr_b16 v[32:33], v4 offset:16384
    v_mfma_f32_16x16x32_bf16 v[212:215], v[52:55], v[88:91], v[212:215]
    ds_read_b64_tr_b16 v[34:35], v4 offset:18432
    v_mfma_f32_16x16x32_bf16 v[212:215], v[68:71], v[92:95], v[212:215]
    ds_read_b64_tr_b16 v[36:37], v5 offset:16384
    v_mfma_f32_16x16x32_bf16 v[208:211], v[64:67], v[92:95], v[208:211]
    ds_read_b64_tr_b16 v[38:39], v5 offset:18432
    v_mfma_f32_16x16x32_bf16 v[208:211], v[48:51], v[88:91], v[208:211]
    ds_read_b64_tr_b16 v[20:21], v5 offset:0
    v_mfma_f32_16x16x32_bf16 v[224:227], v[48:51], v[96:99], v[224:227]
    ds_read_b128 v[88:91], v2 offset:2048
    v_mfma_f32_16x16x32_bf16 v[224:227], v[64:67], v[100:103], v[224:227]
    ds_read_b128 v[92:95], v3 offset:2048
    v_mfma_f32_16x16x32_bf16 v[228:231], v[68:71], v[100:103], v[228:231]
    ds_read_b64_tr_b16 v[22:23], v5 offset:2048
    v_mfma_f32_16x16x32_bf16 v[228:231], v[52:55], v[96:99], v[228:231]
    ds_read_b64_tr_b16 v[24:25], v6 offset:0
    v_mfma_f32_16x16x32_bf16 v[232:235], v[56:59], v[96:99], v[232:235]
    ds_read_b64_tr_b16 v[26:27], v6 offset:2048
    v_mfma_f32_16x16x32_bf16 v[232:235], v[72:75], v[100:103], v[232:235]
    ds_read_b64_tr_b16 v[40:41], v6 offset:16384
    v_mfma_f32_16x16x32_bf16 v[236:239], v[76:79], v[100:103], v[236:239]
    ds_read_b64_tr_b16 v[42:43], v6 offset:18432
    v_mfma_f32_16x16x32_bf16 v[236:239], v[60:63], v[96:99], v[236:239]
    ds_read_b64_tr_b16 v[44:45], v7 offset:16384
    v_mfma_f32_16x16x32_bf16 v[252:255], v[60:63], v[104:107], v[252:255]
    ds_read_b128 v[96:99], v2 offset:4096
    v_mfma_f32_16x16x32_bf16 v[252:255], v[76:79], v[108:111], v[252:255]
    ds_read_b128 v[100:103], v3 offset:4096
    v_mfma_f32_16x16x32_bf16 v[248:251], v[72:75], v[108:111], v[248:251]
    ds_read_b64_tr_b16 v[46:47], v7 offset:18432
    v_mfma_f32_16x16x32_bf16 v[248:251], v[56:59], v[104:107], v[248:251]
    ds_read_b64_tr_b16 v[28:29], v7 offset:0
    v_mfma_f32_16x16x32_bf16 v[244:247], v[52:55], v[104:107], v[244:247]
    ds_read_b64_tr_b16 v[30:31], v7 offset:2048
    v_mfma_f32_16x16x32_bf16 v[244:247], v[68:71], v[108:111], v[244:247]
    v_mfma_f32_16x16x32_bf16 v[240:243], v[64:67], v[108:111], v[240:243]
    s_sub_u32 s52, s52, 1
    s_cmp_lg_u32 s52, 0
    v_mfma_f32_16x16x32_bf16 v[240:243], v[48:51], v[104:107], v[240:243]
    ds_read_b128 v[104:107], v2 offset:6144
    ds_read_b128 v[108:111], v3 offset:6144
    s_cbranch_scc1 L_c_loop
    s_waitcnt lgkmcnt(2)
    v_mfma_f32_16x16x32_bf16 v[128:131], v[16:19], v[80:83], v[128:131]
    v_mfma_f32_16x16x32_bf16 v[128:131], v[32:35], v[84:87], v[128:131]
    v_mfma_f32_16x16x32_bf16 v[132:135], v[36:39], v[84:87], v[132:135]
    v_mfma_f32_16x16x32_bf16 v[132:135], v[20:23], v[80:83], v[132:135]
    v_mfma_f32_16x16x32_bf16 v[136:139], v[24:27], v[80:83], v[136:139]
    v_mfma_f32_16x16x32_bf16 v[136:139], v[40:43], v[84:87], v[136:139]
    v_mfma_f32_16x16x32_bf16 v[140:143], v[44:47], v[84:87], v[140:143]
    v_mfma_f32_16x16x32_bf16 v[140:143], v[28:31], v[80:83], v[140:143]
    v_mfma_f32_16x16x32_bf16 v[156:159], v[28:31], v[88:91], v[156:159]
    ds_read_b128 v[80:83], v2 offset:8192
    v_mfma_f32_16x16x32_bf16 v[156:159], v[44:47], v[92:95], v[156:159]
    ds_read_b128 v[84:87], v3 offset:8192
    v_mfma_f32_16x16x32_bf16 v[152:155], v[40:43], v[92:95], v[152:155]
    s_add_u32 s51, s51, 49152
    v_mfma_f32_16x16x32_bf16 v[152:155], v[24:27], v[88:91], v[152:155]
    s_cmp_eq_u32 s51, 147456
    v_mfma_f32_16x16x32_bf16 v[148:151], v[20:23], v[88:91], v[148:151]
    s_cselect_b32 s64, s65, s66
    v_mfma_f32_16x16x32_bf16 v[148:151], v[36:39], v[92:95], v[148:151]
    s_cselect_b32 s51, 0, s51
    v_mfma_f32_16x16x32_bf16 v[144:147], v[32:35], v[92:95], v[144:147]
    v_add_u32 v4, s64, v4
    v_mfma_f32_16x16x32_bf16 v[144:147], v[16:19], v[88:91], v[144:147]
    v_add_u32 v5, s64, v5
    v_mfma_f32_16x16x32_bf16 v[160:163], v[16:19], v[96:99], v[160:163]
    ds_read_b128 v[88:91], v2 offset:10240
    v_mfma_f32_16x16x32_bf16 v[160:163], v[32:35], v[100:103], v[160:163]
    ds_read_b128 v[92:95], v3 offset:10240
    v_mfma_f32_16x16x32_bf16 v[164:167], v[36:39], v[100:103], v[164:167]
    v_add_u32 v6, s64, v6
    v_mfma_f32_16x16x32_bf16 v[164:167], v[20:23], v[96:99], v[164:167]
    v_add_u32 v7, s64, v7
    v_mfma_f32_16x16x32_bf16 v[168:171], v[24:27], v[96:99], v[168:171]
    v_mfma_f32_16x16x32_bf16 v[168:171], v[40:43], v[100:103], v[168:171]
    v_mfma_f32_16x16x32_bf16 v[172:175], v[44:47], v[100:103], v[172:175]
    v_mfma_f32_16x16x32_bf16 v[172:175], v[28:31], v[96:99], v[172:175]
    s_waitcnt lgkmcnt(4)
    v_mfma_f32_16x16x32_bf16 v[188:191], v[28:31], v[104:107], v[188:191]
    ds_read_b128 v[96:99], v2 offset:12288
    v_mfma_f32_16x16x32_bf16 v[188:191], v[44:47], v[108:111], v[188:191]
    ds_read_b128 v[100:103], v3 offset:12288
    v_mfma_f32_16x16x32_bf16 v[184:187], v[40:43], v[108:111], v[184:187]
    v_mfma_f32_16x16x32_bf16 v[184:187], v[24:27], v[104:107], v[184:187]
    v_mfma_f32_16x16x32_bf16 v[180:183], v[20:23], v[104:107], v[180:183]
    v_mfma_f32_16x16x32_bf16 v[180:183], v[36:39], v[108:111], v[180:183]
    v_mfma_f32_16x16x32_bf16 v[176:179], v[32:35], v[108:111], v[176:179]
    v_mfma_f32_16x16x32_bf16 v[176:179], v[16:19], v[104:107], v[176:179]
    s_waitcnt lgkmcnt(4)
    v_mfma_f32_16x16x32_bf16 v[192:195], v[16:19], v[80:83], v[192:195]
    ds_read_b128 v[104:107], v2 offset:14336
    v_mfma_f32_16x16x32_bf16 v[192:195], v[32:35], v[84:87], v[192:195]
    ds_read_b128 v[108:111], v3 offset:14336
    v_mfma_f32_16x16x32_bf16 v[196:199], v[36:39], v[84:87], v[196:199]
    v_add_u32 v2, s64, v2
    v_mfma_f32_16x16x32_bf16 v[196:199], v[20:23], v[80:83], v[196:199]
    v_add_u32 v3, s64, v3
    v_mfma_f32_16x16x32_bf16 v[200:203], v[24:27], v[80:83], v[200:203]
    v_mfma_f32_16x16x32_bf16 v[200:203], v[40:43], v[84:87], v[200:203]
    v_mfma_f32_16x16x32_bf16 v[204:207], v[44:47], v[84:87], v[204:207]
    s_waitcnt lgkmcnt(0)
    s_barrier
    v_mfma_f32_16x16x32_bf16 v[204:207], v[28:31], v[80:83], v[204:207]
    ds_read_b64_tr_b16 v[48:49], v4 offset:0
    v_mfma_f32_16x16x32_bf16 v[220:223], v[28:31], v[88:91], v[220:223]
    ds_read_b128 v[80:83], v2 offset:0
    v_mfma_f32_16x16x32_bf16 v[220:223], v[44:47], v[92:95], v[220:223]
    ds_read_b128 v[84:87], v3 offset:0
    v_mfma_f32_16x16x32_bf16 v[216:219], v[40:43], v[92:95], v[216:219]
    ds_read_b64_tr_b16 v[50:51], v4 offset:2048
    v_mfma_f32_16x16x32_bf16 v[216:219], v[24:27], v[88:91], v[216:219]
    ds_read_b64_tr_b16 v[64:65], v4 offset:16384
    v_mfma_f32_16x16x32_bf16 v[212:215], v[20:23], v[88:91], v[212:215]
    ds_read_b64_tr_b16 v[66:67], v4 offset:18432
    v_mfma_f32_16x16x32_bf16 v[212:215], v[36:39], v[92:95], v[212:215]
    ds_read_b64_tr_b16 v[68:69], v5 offset:16384
    v_mfma_f32_16x16x32_bf16 v[208:211], v[32:35], v[92:95], v[208:211]
    ds_read_b64_tr_b16 v[70:71], v5 offset:18432
    v_mfma_f32_16x16x32_bf16 v[208:211], v[16:19], v[88:91], v[208:211]
    ds_read_b64_tr_b16 v[52:53], v5 offset:0
    v_mfma_f32_16x16x32_bf16 v[224:227], v[16:19], v[96:99], v[224:227]
    ds_read_b128 v[88:91], v2 offset:2048
    v_mfma_f32_16x16x32_bf16 v[224:227], v[32:35], v[100:103], v[224:227]
    ds_read_b128 v[92:95], v3 offset:2048
    v_mfma_f32_16x16x32_bf16 v[228:231], v[36:39], v[100:103], v[228:231]
    ds_read_b64_tr_b16 v[54:55], v5 offset:2048
    v_mfma_f32_16x16x32_bf16 v[228:231], v[20:23], v[96:99], v[228:231]
    ds_read_b64_tr_b16 v[56:57], v6 offset:0
    v_mfma_f32_16x16x32_bf16 v[232:235], v[24:27], v[96:99], v[232:235]
    ds_read_b64_tr_b16 v[58:59], v6 offset:2048
    v_mfma_f32_16x16x32_bf16 v[232:235], v[40:43], v[100:103], v[232:235]
    ds_read_b64_tr_b16 v[72:73], v6 offset:16384
    v_mfma_f32_16x16x32_bf16 v[236:239], v[44:47], v[100:103], v[236:239]
    ds_read_b64_tr_b16 v[74:75], v6 offset:18432
    v_mfma_f32_16x16x32_bf16 v[236:239], v[28:31], v[96:99], v[236:239]
    ds_read_b64_tr_b16 v[76:77], v7 offset:16384
    v_mfma_f32_16x16x32_bf16 v[252:255], v[28:31], v[104:107], v[252:255]
    ds_read_b128 v[96:99], v2 offset:4096
    v_mfma_f32_16x16x32_bf16 v[252:255], v[44:47], v[108:111], v[252:255]
    ds_read_b128 v[100:103], v3 offset:4096
    v_mfma_f32_16x16x32_bf16 v[248:251], v[40:43], v[108:111], v[248:251]
    ds_read_b64_tr_b16 v[78:79], v7 offset:18432
    v_mfma_f32_16x16x32_bf16 v[248:251], v[24:27], v[104:107], v[248:251]
    ds_read_b64_tr_b16 v[60:61], v7 offset:0
    v_mfma_f32_16x16x32_bf16 v[244:247], v[20:23], v[104:107], v[244:247]
    ds_read_b64_tr_b16 v[62:63], v7 offset:2048
    v_mfma_f32_16x16x32_bf16 v[244:247], v[36:39], v[108:111], v[244:247]
    v_mfma_f32_16x16x32_bf16 v[240:243], v[32:35], v[108:111], v[240:243]
    v_mfma_f32_16x16x32_bf16 v[240:243], v[16:19], v[104:107], v[240:243]
    ds_read_b128 v[104:107], v2 offset:6144
    ds_read_b128 v[108:111], v3 offset:6144
    s_waitcnt lgkmcnt(2)
    v_mfma_f32_16x16x32_bf16 v[128:131], v[48:51], v[80:83], v[128:131]
    v_mfma_f32_16x16x32_bf16 v[128:131], v[64:67], v[84:87], v[128:131]
    v_mfma_f32_16x16x32_bf16 v[132:135], v[68:71], v[84:87], v[132:135]
    v_mfma_f32_16x16x32_bf16 v[132:135], v[52:55], v[80:83], v[132:135]
    v_mfma_f32_16x16x32_bf16 v[136:139], v[56:59], v[80:83], v[136:139]
    v_mfma_f32_16x16x32_bf16 v[136:139], v[72:75], v[84:87], v[136:139]
    v_mfma_f32_16x16x32_bf16 v[140:143], v[76:79], v[84:87], v[140:143]
    v_mfma_f32_16x16x32_bf16 v[140:143], v[60:63], v[80:83], v[140:143]
    v_mfma_f32_16x16x32_bf16 v[156:159], v[60:63], v[88:91], v[156:159]
    ds_read_b128 v[80:83], v2 offset:8192
    v_mfma_f32_16x16x32_bf16 v[156:159], v[76:79], v[92:95], v[156:159]
    ds_read_b128 v[84:87], v3 offset:8192
    v_mfma_f32_16x16x32_bf16 v[152:155], v[72:75], v[92:95], v[152:155]
    v_mfma_f32_16x16x32_bf16 v[152:155], v[56:59], v[88:91], v[152:155]
    v_mfma_f32_16x16x32_bf16 v[148:151], v[52:55], v[88:91], v[148:151]
    v_mfma_f32_16x16x32_bf16 v[148:151], v[68:71], v[92:95], v[148:151]
    v_mfma_f32_16x16x32_bf16 v[144:147], v[64:67], v[92:95], v[144:147]
    v_mfma_f32_16x16x32_bf16 v[144:147], v[48:51], v[88:91], v[144:147]
    v_mfma_f32_16x16x32_bf16 v[160:163], v[48:51], v[96:99], v[160:163]
    ds_read_b128 v[88:91], v2 offset:10240
    v_mfma_f32_16x16x32_bf16 v[160:163], v[64:67], v[100:103], v[160:163]
    ds_read_b128 v[92:95], v3 offset:10240
    v_mfma_f32_16x16x32_bf16 v[164:167], v[68:71], v[100:103], v[164:167]
    v_mfma_f32_16x16x32_bf16 v[164:167], v[52:55], v[96:99], v[164:167]
    v_mfma_f32_16x16x32_bf16 v[168:171], v[56:59], v[96:99], v[168:171]
    v_mfma_f32_16x16x32_bf16 v[168:171], v[72:75], v[100:103], v[168:171]
    v_mfma_f32_16x16x32_bf16 v[172:175], v[76:79], v[100:103], v[172:175]
    v_mfma_f32_16x16x32_bf16 v[172:175], v[60:63], v[96:99], v[172:175]
    s_waitcnt lgkmcnt(4)
    v_mfma_f32_16x16x32_bf16 v[188:191], v[60:63], v[104:107], v[188:191]
    ds_read_b128 v[96:99], v2 offset:12288
    v_mfma_f32_16x16x32_bf16 v[188:191], v[76:79], v[108:111], v[188:191]
    ds_read_b128 v[100:103], v3 offset:12288
    v_mfma_f32_16x16x32_bf16 v[184:187], v[72:75], v[108:111], v[184:187]
    v_mfma_f32_16x16x32_bf16 v[184:187], v[56:59], v[104:107], v[184:187]
    v_mfma_f32_16x16x32_bf16 v[180:183], v[52:55], v[104:107], v[180:183]
    v_mfma_f32_16x16x32_bf16 v[180:183], v[68:71], v[108:111], v[180:183]
    v_mfma_f32_16x16x32_bf16 v[176:179], v[64:67], v[108:111], v[176:179]
    v_mfma_f32_16x16x32_bf16 v[176:179], v[48:51], v[104:107], v[176:179]
    s_waitcnt lgkmcnt(4)
    v_mfma_f32_16x16x32_bf16 v[192:195], v[48:51], v[80:83], v[192:195]
    ds_read_b128 v[104:107], v2 offset:14336
    v_mfma_f32_16x16x32_bf16 v[192:195], v[64:67], v[84:87], v[192:195]
    ds_read_b128 v[108:111], v3 offset:14336
    v_mfma_f32_16x16x32_bf16 v[196:199], v[68:71], v[84:87], v[196:199]
    v_mfma_f32_16x16x32_bf16 v[196:199], v[52:55], v[80:83], v[196:199]
    v_mfma_f32_16x16x32_bf16 v[200:203], v[56:59], v[80:83], v[200:203]
    v_mfma_f32_16x16x32_bf16 v[200:203], v[72:75], v[84:87], v[200:203]
    v_mfma_f32_16x16x32_bf16 v[204:207], v[76:79], v[84:87], v[204:207]
    v_mfma_f32_16x16x32_bf16 v[204:207], v[60:63], v[80:83], v[204:207]
    s_waitcnt lgkmcnt(4)
    v_mfma_f32_16x16x32_bf16 v[220:223], v[60:63], v[88:91], v[220:223]
    v_mfma_f32_16x16x32_bf16 v[220:223], v[76:79], v[92:95], v[220:223]
    v_mfma_f32_16x16x32_bf16 v[216:219], v[72:75], v[92:95], v[216:219]
    v_mfma_f32_16x16x32_bf16 v[216:219], v[56:59], v[88:91], v[216:219]
    v_mfma_f32_16x16x32_bf16 v[212:215], v[52:55], v[88:91], v[212:215]
    v_mfma_f32_16x16x32_bf16 v[212:215], v[68:71], v[92:95], v[212:215]
    v_mfma_f32_16x16x32_bf16 v[208:211], v[64:67], v[92:95], v[208:211]
    v_mfma_f32_16x16x32_bf16 v[208:211], v[48:51], v[88:91], v[208:211]
    s_waitcnt lgkmcnt(2)
    v_mfma_f32_16x16x32_bf16 v[224:227], v[48:51], v[96:99], v[224:227]
    v_mfma_f32_16x16x32_bf16 v[224:227], v[64:67], v[100:103], v[224:227]
    v_mfma_f32_16x16x32_bf16 v[228:231], v[68:71], v[100:103], v[228:231]
    v_mfma_f32_16x16x32_bf16 v[228:231], v[52:55], v[96:99], v[228:231]
    v_mfma_f32_16x16x32_bf16 v[232:235], v[56:59], v[96:99], v[232:235]
    v_mfma_f32_16x16x32_bf16 v[232:235], v[72:75], v[100:103], v[232:235]
    v_mfma_f32_16x16x32_bf16 v[236:239], v[76:79], v[100:103], v[236:239]
    v_mfma_f32_16x16x32_bf16 v[236:239], v[60:63], v[96:99], v[236:239]
    s_waitcnt lgkmcnt(0)
    v_mfma_f32_16x16x32_bf16 v[252:255], v[60:63], v[104:107], v[252:255]
    v_mfma_f32_16x16x32_bf16 v[252:255], v[76:79], v[108:111], v[252:255]
    v_mfma_f32_16x16x32_bf16 v[248:251], v[72:75], v[108:111], v[248:251]
    v_mfma_f32_16x16x32_bf16 v[248:251], v[56:59], v[104:107], v[248:251]
    v_mfma_f32_16x16x32_bf16 v[244:247], v[52:55], v[104:107], v[244:247]
    v_mfma_f32_16x16x32_bf16 v[244:247], v[68:71], v[108:111], v[244:247]
    v_mfma_f32_16x16x32_bf16 v[240:243], v[64:67], v[108:111], v[240:243]
    v_mfma_f32_16x16x32_bf16 v[240:243], v[48:51], v[104:107], v[240:243]
    s_waitcnt vmcnt(0) lgkmcnt(0)
    v_lshlrev_b32 v80, 16, v112
    v_and_b32 v81, 0xffff0000, v112
    v_lshlrev_b32 v82, 16, v113
    v_and_b32 v83, 0xffff0000, v113
    v_lshlrev_b32 v84, 16, v114
    v_and_b32 v85, 0xffff0000, v114
    v_lshlrev_b32 v86, 16, v115
    v_and_b32 v87, 0xffff0000, v115
    v_lshlrev_b32 v88, 16, v116
    v_and_b32 v89, 0xffff0000, v116
    v_lshlrev_b32 v90, 16, v117
    v_and_b32 v91, 0xffff0000, v117
    v_lshlrev_b32 v92, 16, v118
    v_and_b32 v93, 0xffff0000, v118
    v_lshlrev_b32 v94, 16, v119
    v_and_b32 v95, 0xffff0000, v119
    s_nop 7
    v_mov_b32 v16, 0
    v_mov_b32 v17, 0
    v_mov_b32 v18, 0
    v_mov_b32 v19, 0
    v_mov_b32 v20, 0
    v_mov_b32 v21, 0
    v_mov_b32 v22, 0
    v_mov_b32 v23, 0
    v_cvt_pk_bf16_f32 v32, v128, v129
    v_cvt_pk_bf16_f32 v36, v144, v145
    v_cvt_pk_bf16_f32 v40, v160, v161
    v_cvt_pk_bf16_f32 v44, v176, v177
    v_cvt_pk_bf16_f32 v48, v192, v193
    v_cvt_pk_bf16_f32 v52, v208, v209
    v_cvt_pk_bf16_f32 v56, v224, v225
    v_cvt_pk_bf16_f32 v60, v240, v241
    v_lshlrev_b32 v34, 16, v32
    v_and_b32 v35, 0xffff0000, v32
    v_lshlrev_b32 v38, 16, v36
    v_and_b32 v39, 0xffff0000, v36
    v_lshlrev_b32 v42, 16, v40
    v_and_b32 v43, 0xffff0000, v40
    v_lshlrev_b32 v46, 16, v44
    v_and_b32 v47, 0xffff0000, v44
    v_lshlrev_b32 v50, 16, v48
    v_and_b32 v51, 0xffff0000, v48
    v_lshlrev_b32 v54, 16, v52
    v_and_b32 v55, 0xffff0000, v52
    v_lshlrev_b32 v58, 16, v56
    v_and_b32 v59, 0xffff0000, v56
    v_lshlrev_b32 v62, 16, v60
    v_and_b32 v63, 0xffff0000, v60
    v_pk_add_f32 v[34:35], v[34:35], v[80:81]
    v_pk_add_f32 v[38:39], v[38:39], v[80:81]
    v_pk_add_f32 v[42:43], v[42:43], v[80:81]
    v_pk_add_f32 v[46:47], v[46:47], v[80:81]
    v_pk_add_f32 v[50:51], v[50:51], v[80:81]
    v_pk_add_f32 v[54:55], v[54:55], v[80:81]
    v_pk_add_f32 v[58:59], v[58:59], v[80:81]
    v_pk_add_f32 v[62:63], v[62:63], v[80:81]
    v_cvt_pk_bf16_f32 v32, v34, v35
    v_cvt_pk_bf16_f32 v36, v38, v39
    v_cvt_pk_bf16_f32 v40, v42, v43
    v_cvt_pk_bf16_f32 v44, v46, v47
    v_cvt_pk_bf16_f32 v48, v50, v51
    v_cvt_pk_bf16_f32 v52, v54, v55
    v_cvt_pk_bf16_f32 v56, v58, v59
    v_cvt_pk_bf16_f32 v60, v62, v63
    v_pk_max_i16 v32, v32, 0
    v_pk_max_i16 v36, v36, 0
    v_pk_max_i16 v40, v40, 0
    v_pk_max_i16 v44, v44, 0
    v_pk_max_i16 v48, v48, 0
    v_pk_max_i16 v52, v52, 0
    v_pk_max_i16 v56, v56, 0
    v_pk_max_i16 v60, v60, 0
    v_dot2_f32_bf16 v16, v32, v120, v16
    v_dot2_f32_bf16 v17, v36, v120, v17
    v_dot2_f32_bf16 v18, v40, v120, v18
    v_dot2_f32_bf16 v19, v44, v120, v19
    v_dot2_f32_bf16 v20, v48, v120, v20
    v_dot2_f32_bf16 v21, v52, v120, v21
    v_dot2_f32_bf16 v22, v56, v120, v22
    v_dot2_f32_bf16 v23, v60, v120, v23
    v_cvt_pk_bf16_f32 v32, v130, v131
    v_cvt_pk_bf16_f32 v36, v146, v147
    v_cvt_pk_bf16_f32 v40, v162, v163
    v_cvt_pk_bf16_f32 v44, v178, v179
    v_cvt_pk_bf16_f32 v48, v194, v195
    v_cvt_pk_bf16_f32 v52, v210, v211
    v_cvt_pk_bf16_f32 v56, v226, v227
    v_cvt_pk_bf16_f32 v60, v242, v243
    v_lshlrev_b32 v34, 16, v32
    v_and_b32 v35, 0xffff0000, v32
    v_lshlrev_b32 v38, 16, v36
    v_and_b32 v39, 0xffff0000, v36
    v_lshlrev_b32 v42, 16, v40
    v_and_b32 v43, 0xffff0000, v40
    v_lshlrev_b32 v46, 16, v44
    v_and_b32 v47, 0xffff0000, v44
    v_lshlrev_b32 v50, 16, v48
    v_and_b32 v51, 0xffff0000, v48
    v_lshlrev_b32 v54, 16, v52
    v_and_b32 v55, 0xffff0000, v52
    v_lshlrev_b32 v58, 16, v56
    v_and_b32 v59, 0xffff0000, v56
    v_lshlrev_b32 v62, 16, v60
    v_and_b32 v63, 0xffff0000, v60
    v_pk_add_f32 v[34:35], v[34:35], v[82:83]
    v_pk_add_f32 v[38:39], v[38:39], v[82:83]
    v_pk_add_f32 v[42:43], v[42:43], v[82:83]
    v_pk_add_f32 v[46:47], v[46:47], v[82:83]
    v_pk_add_f32 v[50:51], v[50:51], v[82:83]
    v_pk_add_f32 v[54:55], v[54:55], v[82:83]
    v_pk_add_f32 v[58:59], v[58:59], v[82:83]
    v_pk_add_f32 v[62:63], v[62:63], v[82:83]
    v_cvt_pk_bf16_f32 v32, v34, v35
    v_cvt_pk_bf16_f32 v36, v38, v39
    v_cvt_pk_bf16_f32 v40, v42, v43
    v_cvt_pk_bf16_f32 v44, v46, v47
    v_cvt_pk_bf16_f32 v48, v50, v51
    v_cvt_pk_bf16_f32 v52, v54, v55
    v_cvt_pk_bf16_f32 v56, v58, v59
    v_cvt_pk_bf16_f32 v60, v62, v63
    v_pk_max_i16 v32, v32, 0
    v_pk_max_i16 v36, v36, 0
    v_pk_max_i16 v40, v40, 0
    v_pk_max_i16 v44, v44, 0
    v_pk_max_i16 v48, v48, 0
    v_pk_max_i16 v52, v52, 0
    v_pk_max_i16 v56, v56, 0
    v_pk_max_i16 v60, v60, 0
    v_dot2_f32_bf16 v16, v32, v121, v16
    v_dot2_f32_bf16 v17, v36, v121, v17
    v_dot2_f32_bf16 v18, v40, v121, v18
    v_dot2_f32_bf16 v19, v44, v121, v19
    v_dot2_f32_bf16 v20, v48, v121, v20
    v_dot2_f32_bf16 v21, v52, v121, v21
    v_dot2_f32_bf16 v22, v56, v121, v22
    v_dot2_f32_bf16 v23, v60, v121, v23
    v_cvt_pk_bf16_f32 v32, v132, v133
    v_cvt_pk_bf16_f32 v36, v148, v149
    v_cvt_pk_bf16_f32 v40, v164, v165
    v_cvt_pk_bf16_f32 v44, v180, v181
    v_cvt_pk_bf16_f32 v48, v196, v197
    v_cvt_pk_bf16_f32 v52, v212, v213
    v_cvt_pk_bf16_f32 v56, v228, v229
    v_cvt_pk_bf16_f32 v60, v244, v245
    v_lshlrev_b32 v34, 16, v32
    v_and_b32 v35, 0xffff0000, v32
    v_lshlrev_b32 v38, 16, v36
    v_and_b32 v39, 0xffff0000, v36
    v_lshlrev_b32 v42, 16, v40
    v_and_b32 v43, 0xffff0000, v40
    v_lshlrev_b32 v46, 16, v44
    v_and_b32 v47, 0xffff0000, v44
    v_lshlrev_b32 v50, 16, v48
    v_and_b32 v51, 0xffff0000, v48
    v_lshlrev_b32 v54, 16, v52
    v_and_b32 v55, 0xffff0000, v52
    v_lshlrev_b32 v58, 16, v56
    v_and_b32 v59, 0xffff0000, v56
    v_lshlrev_b32 v62, 16, v60
    v_and_b32 v63, 0xffff0000, v60
    v_pk_add_f32 v[34:35], v[34:35], v[84:85]
    v_pk_add_f32 v[38:39], v[38:39], v[84:85]
    v_pk_add_f32 v[42:43], v[42:43], v[84:85]
    v_pk_add_f32 v[46:47], v[46:47], v[84:85]
    v_pk_add_f32 v[50:51], v[50:51], v[84:85]
    v_pk_add_f32 v[54:55], v[54:55], v[84:85]
    v_pk_add_f32 v[58:59], v[58:59], v[84:85]
    v_pk_add_f32 v[62:63], v[62:63], v[84:85]
    v_cvt_pk_bf16_f32 v32, v34, v35
    v_cvt_pk_bf16_f32 v36, v38, v39
    v_cvt_pk_bf16_f32 v40, v42, v43
    v_cvt_pk_bf16_f32 v44, v46, v47
    v_cvt_pk_bf16_f32 v48, v50, v51
    v_cvt_pk_bf16_f32 v52, v54, v55
    v_cvt_pk_bf16_f32 v56, v58, v59
    v_cvt_pk_bf16_f32 v60, v62, v63
    v_pk_max_i16 v32, v32, 0
    v_pk_max_i16 v36, v36, 0
    v_pk_max_i16 v40, v40, 0
    v_pk_max_i16 v44, v44, 0
    v_pk_max_i16 v48, v48, 0
    v_pk_max_i16 v52, v52, 0
    v_pk_max_i16 v56, v56, 0
    v_pk_max_i16 v60, v60, 0
    v_dot2_f32_bf16 v16, v32, v122, v16
    v_dot2_f32_bf16 v17, v36, v122, v17
    v_dot2_f32_bf16 v18, v40, v122, v18
    v_dot2_f32_bf16 v19, v44, v122, v19
    v_dot2_f32_bf16 v20, v48, v122, v20
    v_dot2_f32_bf16 v21, v52, v122, v21
    v_dot2_f32_bf16 v22, v56, v122, v22
    v_dot2_f32_bf16 v23, v60, v122, v23
    v_cvt_pk_bf16_f32 v32, v134, v135
    v_cvt_pk_bf16_f32 v36, v150, v151
    v_cvt_pk_bf16_f32 v40, v166, v167
    v_cvt_pk_bf16_f32 v44, v182, v183
    v_cvt_pk_bf16_f32 v48, v198, v199
    v_cvt_pk_bf16_f32 v52, v214, v215
    v_cvt_pk_bf16_f32 v56, v230, v231
    v_cvt_pk_bf16_f32 v60, v246, v247
    v_lshlrev_b32 v34, 16, v32
    v_and_b32 v35, 0xffff0000, v32
    v_lshlrev_b32 v38, 16, v36
    v_and_b32 v39, 0xffff0000, v36
    v_lshlrev_b32 v42, 16, v40
    v_and_b32 v43, 0xffff0000, v40
    v_lshlrev_b32 v46, 16, v44
    v_and_b32 v47, 0xffff0000, v44
    v_lshlrev_b32 v50, 16, v48
    v_and_b32 v51, 0xffff0000, v48
    v_lshlrev_b32 v54, 16, v52
    v_and_b32 v55, 0xffff0000, v52
    v_lshlrev_b32 v58, 16, v56
    v_and_b32 v59, 0xffff0000, v56
    v_lshlrev_b32 v62, 16, v60
    v_and_b32 v63, 0xffff0000, v60
    v_pk_add_f32 v[34:35], v[34:35], v[86:87]
    v_pk_add_f32 v[38:39], v[38:39], v[86:87]
    v_pk_add_f32 v[42:43], v[42:43], v[86:87]
    v_pk_add_f32 v[46:47], v[46:47], v[86:87]
    v_pk_add_f32 v[50:51], v[50:51], v[86:87]
    v_pk_add_f32 v[54:55], v[54:55], v[86:87]
    v_pk_add_f32 v[58:59], v[58:59], v[86:87]
    v_pk_add_f32 v[62:63], v[62:63], v[86:87]
    v_cvt_pk_bf16_f32 v32, v34, v35
    v_cvt_pk_bf16_f32 v36, v38, v39
    v_cvt_pk_bf16_f32 v40, v42, v43
    v_cvt_pk_bf16_f32 v44, v46, v47
    v_cvt_pk_bf16_f32 v48, v50, v51
    v_cvt_pk_bf16_f32 v52, v54, v55
    v_cvt_pk_bf16_f32 v56, v58, v59
    v_cvt_pk_bf16_f32 v60, v62, v63
    v_pk_max_i16 v32, v32, 0
    v_pk_max_i16 v36, v36, 0
    v_pk_max_i16 v40, v40, 0
    v_pk_max_i16 v44, v44, 0
    v_pk_max_i16 v48, v48, 0
    v_pk_max_i16 v52, v52, 0
    v_pk_max_i16 v56, v56, 0
    v_pk_max_i16 v60, v60, 0
    v_dot2_f32_bf16 v16, v32, v123, v16
    v_dot2_f32_bf16 v17, v36, v123, v17
    v_dot2_f32_bf16 v18, v40, v123, v18
    v_dot2_f32_bf16 v19, v44, v123, v19
    v_dot2_f32_bf16 v20, v48, v123, v20
    v_dot2_f32_bf16 v21, v52, v123, v21
    v_dot2_f32_bf16 v22, v56, v123, v22
    v_dot2_f32_bf16 v23, v60, v123, v23
    v_cvt_pk_bf16_f32 v32, v136, v137
    v_cvt_pk_bf16_f32 v36, v152, v153
    v_cvt_pk_bf16_f32 v40, v168, v169
    v_cvt_pk_bf16_f32 v44, v184, v185
    v_cvt_pk_bf16_f32 v48, v200, v201
    v_cvt_pk_bf16_f32 v52, v216, v217
    v_cvt_pk_bf16_f32 v56, v232, v233
    v_cvt_pk_bf16_f32 v60, v248, v249
    v_lshlrev_b32 v34, 16, v32
    v_and_b32 v35, 0xffff0000, v32
    v_lshlrev_b32 v38, 16, v36
    v_and_b32 v39, 0xffff0000, v36
    v_lshlrev_b32 v42, 16, v40
    v_and_b32 v43, 0xffff0000, v40
    v_lshlrev_b32 v46, 16, v44
    v_and_b32 v47, 0xffff0000, v44
    v_lshlrev_b32 v50, 16, v48
    v_and_b32 v51, 0xffff0000, v48
    v_lshlrev_b32 v54, 16, v52
    v_and_b32 v55, 0xffff0000, v52
    v_lshlrev_b32 v58, 16, v56
    v_and_b32 v59, 0xffff0000, v56
    v_lshlrev_b32 v62, 16, v60
    v_and_b32 v63, 0xffff0000, v60
    v_pk_add_f32 v[34:35], v[34:35], v[88:89]
    v_pk_add_f32 v[38:39], v[38:39], v[88:89]
    v_pk_add_f32 v[42:43], v[42:43], v[88:89]
    v_pk_add_f32 v[46:47], v[46:47], v[88:89]
    v_pk_add_f32 v[50:51], v[50:51], v[88:89]
    v_pk_add_f32 v[54:55], v[54:55], v[88:89]
    v_pk_add_f32 v[58:59], v[58:59], v[88:89]
    v_pk_add_f32 v[62:63], v[62:63], v[88:89]
    v_cvt_pk_bf16_f32 v32, v34, v35
    v_cvt_pk_bf16_f32 v36, v38, v39
    v_cvt_pk_bf16_f32 v40, v42, v43
    v_cvt_pk_bf16_f32 v44, v46, v47
    v_cvt_pk_bf16_f32 v48, v50, v51
    v_cvt_pk_bf16_f32 v52, v54, v55
    v_cvt_pk_bf16_f32 v56, v58, v59
    v_cvt_pk_bf16_f32 v60, v62, v63
    v_pk_max_i16 v32, v32, 0
    v_pk_max_i16 v36, v36, 0
    v_pk_max_i16 v40, v40, 0
    v_pk_max_i16 v44, v44, 0
    v_pk_max_i16 v48, v48, 0
    v_pk_max_i16 v52, v52, 0
    v_pk_max_i16 v56, v56, 0
    v_pk_max_i16 v60, v60, 0
    v_dot2_f32_bf16 v16, v32, v124, v16
    v_dot2_f32_bf16 v17, v36, v124, v17
    v_dot2_f32_bf16 v18, v40, v124, v18
    v_dot2_f32_bf16 v19, v44, v124, v19
    v_dot2_f32_bf16 v20, v48, v124, v20
    v_dot2_f32_bf16 v21, v52, v124, v21
    v_dot2_f32_bf16 v22, v56, v124, v22
    v_dot2_f32_bf16 v23, v60, v124, v23
    v_cvt_pk_bf16_f32 v32, v138, v139
    v_cvt_pk_bf16_f32 v36, v154, v155
    v_cvt_pk_bf16_f32 v40, v170, v171
    v_cvt_pk_bf16_f32 v44, v186, v187
    v_cvt_pk_bf16_f32 v48, v202, v203
    v_cvt_pk_bf16_f32 v52, v218, v219
    v_cvt_pk_bf16_f32 v56, v234, v235
    v_cvt_pk_bf16_f32 v60, v250, v251
    v_lshlrev_b32 v34, 16, v32
    v_and_b32 v35, 0xffff0000, v32
    v_lshlrev_b32 v38, 16, v36
    v_and_b32 v39, 0xffff0000, v36
    v_lshlrev_b32 v42, 16, v40
    v_and_b32 v43, 0xffff0000, v40
    v_lshlrev_b32 v46, 16, v44
    v_and_b32 v47, 0xffff0000, v44
    v_lshlrev_b32 v50, 16, v48
    v_and_b32 v51, 0xffff0000, v48
    v_lshlrev_b32 v54, 16, v52
    v_and_b32 v55, 0xffff0000, v52
    v_lshlrev_b32 v58, 16, v56
    v_and_b32 v59, 0xffff0000, v56
    v_lshlrev_b32 v62, 16, v60
    v_and_b32 v63, 0xffff0000, v60
    v_pk_add_f32 v[34:35], v[34:35], v[90:91]
    v_pk_add_f32 v[38:39], v[38:39], v[90:91]
    v_pk_add_f32 v[42:43], v[42:43], v[90:91]
    v_pk_add_f32 v[46:47], v[46:47], v[90:91]
    v_pk_add_f32 v[50:51], v[50:51], v[90:91]
    v_pk_add_f32 v[54:55], v[54:55], v[90:91]
    v_pk_add_f32 v[58:59], v[58:59], v[90:91]
    v_pk_add_f32 v[62:63], v[62:63], v[90:91]
    v_cvt_pk_bf16_f32 v32, v34, v35
    v_cvt_pk_bf16_f32 v36, v38, v39
    v_cvt_pk_bf16_f32 v40, v42, v43
    v_cvt_pk_bf16_f32 v44, v46, v47
    v_cvt_pk_bf16_f32 v48, v50, v51
    v_cvt_pk_bf16_f32 v52, v54, v55
    v_cvt_pk_bf16_f32 v56, v58, v59
    v_cvt_pk_bf16_f32 v60, v62, v63
    v_pk_max_i16 v32, v32, 0
    v_pk_max_i16 v36, v36, 0
    v_pk_max_i16 v40, v40, 0
    v_pk_max_i16 v44, v44, 0
    v_pk_max_i16 v48, v48, 0
    v_pk_max_i16 v52, v52, 0
    v_pk_max_i16 v56, v56, 0
    v_pk_max_i16 v60, v60, 0
    v_dot2_f32_bf16 v16, v32, v125, v16
    v_dot2_f32_bf16 v17, v36, v125, v17
    v_dot2_f32_bf16 v18, v40, v125, v18
    v_dot2_f32_bf16 v19, v44, v125, v19
    v_dot2_f32_bf16 v20, v48, v125, v20
    v_dot2_f32_bf16 v21, v52, v125, v21
    v_dot2_f32_bf16 v22, v56, v125, v22
    v_dot2_f32_bf16 v23, v60, v125, v23
    v_cvt_pk_bf16_f32 v32, v140, v141
    v_cvt_pk_bf16_f32 v36, v156, v157
    v_cvt_pk_bf16_f32 v40, v172, v173
    v_cvt_pk_bf16_f32 v44, v188, v189
    v_cvt_pk_bf16_f32 v48, v204, v205
    v_cvt_pk_bf16_f32 v52, v220, v221
    v_cvt_pk_bf16_f32 v56, v236, v237
    v_cvt_pk_bf16_f32 v60, v252, v253
    v_lshlrev_b32 v34, 16, v32
    v_and_b32 v35, 0xffff0000, v32
    v_lshlrev_b32 v38, 16, v36
    v_and_b32 v39, 0xffff0000, v36
    v_lshlrev_b32 v42, 16, v40
    v_and_b32 v43, 0xffff0000, v40
    v_lshlrev_b32 v46, 16, v44
    v_and_b32 v47, 0xffff0000, v44
    v_lshlrev_b32 v50, 16, v48
    v_and_b32 v51, 0xffff0000, v48
    v_lshlrev_b32 v54, 16, v52
    v_and_b32 v55, 0xffff0000, v52
    v_lshlrev_b32 v58, 16, v56
    v_and_b32 v59, 0xffff0000, v56
    v_lshlrev_b32 v62, 16, v60
    v_and_b32 v63, 0xffff0000, v60
    v_pk_add_f32 v[34:35], v[34:35], v[92:93]
    v_pk_add_f32 v[38:39], v[38:39], v[92:93]
    v_pk_add_f32 v[42:43], v[42:43], v[92:93]
    v_pk_add_f32 v[46:47], v[46:47], v[92:93]
    v_pk_add_f32 v[50:51], v[50:51], v[92:93]
    v_pk_add_f32 v[54:55], v[54:55], v[92:93]
    v_pk_add_f32 v[58:59], v[58:59], v[92:93]
    v_pk_add_f32 v[62:63], v[62:63], v[92:93]
    v_cvt_pk_bf16_f32 v32, v34, v35
    v_cvt_pk_bf16_f32 v36, v38, v39
    v_cvt_pk_bf16_f32 v40, v42, v43
    v_cvt_pk_bf16_f32 v44, v46, v47
    v_cvt_pk_bf16_f32 v48, v50, v51
    v_cvt_pk_bf16_f32 v52, v54, v55
    v_cvt_pk_bf16_f32 v56, v58, v59
    v_cvt_pk_bf16_f32 v60, v62, v63
    v_pk_max_i16 v32, v32, 0
    v_pk_max_i16 v36, v36, 0
    v_pk_max_i16 v40, v40, 0
    v_pk_max_i16 v44, v44, 0
    v_pk_max_i16 v48, v48, 0
    v_pk_max_i16 v52, v52, 0
    v_pk_max_i16 v56, v56, 0
    v_pk_max_i16 v60, v60, 0
    v_dot2_f32_bf16 v16, v32, v126, v16
    v_dot2_f32_bf16 v17, v36, v126, v17
    v_dot2_f32_bf16 v18, v40, v126, v18
    v_dot2_f32_bf16 v19, v44, v126, v19
    v_dot2_f32_bf16 v20, v48, v126, v20
    v_dot2_f32_bf16 v21, v52, v126, v21
    v_dot2_f32_bf16 v22, v56, v126, v22
    v_dot2_f32_bf16 v23, v60, v126, v23
    v_cvt_pk_bf16_f32 v32, v142, v143
    v_cvt_pk_bf16_f32 v36, v158, v159
    v_cvt_pk_bf16_f32 v40, v174, v175
    v_cvt_pk_bf16_f32 v44, v190, v191
    v_cvt_pk_bf16_f32 v48, v206, v207
    v_cvt_pk_bf16_f32 v52, v222, v223
    v_cvt_pk_bf16_f32 v56, v238, v239
    v_cvt_pk_bf16_f32 v60, v254, v255
    v_lshlrev_b32 v34, 16, v32
    v_and_b32 v35, 0xffff0000, v32
    v_lshlrev_b32 v38, 16, v36
    v_and_b32 v39, 0xffff0000, v36
    v_lshlrev_b32 v42, 16, v40
    v_and_b32 v43, 0xffff0000, v40
    v_lshlrev_b32 v46, 16, v44
    v_and_b32 v47, 0xffff0000, v44
    v_lshlrev_b32 v50, 16, v48
    v_and_b32 v51, 0xffff0000, v48
    v_lshlrev_b32 v54, 16, v52
    v_and_b32 v55, 0xffff0000, v52
    v_lshlrev_b32 v58, 16, v56
    v_and_b32 v59, 0xffff0000, v56
    v_lshlrev_b32 v62, 16, v60
    v_and_b32 v63, 0xffff0000, v60
    v_pk_add_f32 v[34:35], v[34:35], v[94:95]
    v_pk_add_f32 v[38:39], v[38:39], v[94:95]
    v_pk_add_f32 v[42:43], v[42:43], v[94:95]
    v_pk_add_f32 v[46:47], v[46:47], v[94:95]
    v_pk_add_f32 v[50:51], v[50:51], v[94:95]
    v_pk_add_f32 v[54:55], v[54:55], v[94:95]
    v_pk_add_f32 v[58:59], v[58:59], v[94:95]
    v_pk_add_f32 v[62:63], v[62:63], v[94:95]
    v_cvt_pk_bf16_f32 v32, v34, v35
    v_cvt_pk_bf16_f32 v36, v38, v39
    v_cvt_pk_bf16_f32 v40, v42, v43
    v_cvt_pk_bf16_f32 v44, v46, v47
    v_cvt_pk_bf16_f32 v48, v50, v51
    v_cvt_pk_bf16_f32 v52, v54, v55
    v_cvt_pk_bf16_f32 v56, v58, v59
    v_cvt_pk_bf16_f32 v60, v62, v63
    v_pk_max_i16 v32, v32, 0
    v_pk_max_i16 v36, v36, 0
    v_pk_max_i16 v40, v40, 0
    v_pk_max_i16 v44, v44, 0
    v_pk_max_i16 v48, v48, 0
    v_pk_max_i16 v52, v52, 0
    v_pk_max_i16 v56, v56, 0
    v_pk_max_i16 v60, v60, 0
    v_dot2_f32_bf16 v16, v32, v127, v16
    v_dot2_f32_bf16 v17, v36, v127, v17
    v_dot2_f32_bf16 v18, v40, v127, v18
    v_dot2_f32_bf16 v19, v44, v127, v19
    v_dot2_f32_bf16 v20, v48, v127, v20
    v_dot2_f32_bf16 v21, v52, v127, v21
    v_dot2_f32_bf16 v22, v56, v127, v22
    v_dot2_f32_bf16 v23, v60, v127, v23
    v_and_b32 v14, 15, v0
    v_lshrrev_b32 v15, 4, v0
    v_lshlrev_b32 v14, 2, v14
    v_lshl_add_u32 v14, v15, 9, v14
    s_lshl_b32 s55, s3, 11
    s_add_u32 s55, s55, 147456
    v_add_u32 v14, s55, v14
    s_nop 3
    ds_write_b32 v14, v16 offset:0
    ds_write_b32 v14, v17 offset:64
    ds_write_b32 v14, v18 offset:128
    ds_write_b32 v14, v19 offset:192
    ds_write_b32 v14, v20 offset:256
    ds_write_b32 v14, v21 offset:320
    ds_write_b32 v14, v22 offset:384
    ds_write_b32 v14, v23 offset:448
    s_waitcnt lgkmcnt(0)
    s_barrier
    s_endpgm
L_loader:
    buffer_load_dwordx4 v[56:59], v33, s[44:47], s56 offen
    s_sub_u32 s3, s3, 4
    v_lshrrev_b32 v30, 3, v0
    s_lshl_b32 s55, s3, 5
    s_add_u32 s55, s55, s50
    v_add_u32 v31, s55, v30
    v_mul_u32_u24 v31, 104, v31
    v_and_b32 v30, 7, v0
    v_lshl_add_u32 v5, v30, 4, v31
    v_mov_b32 v20, 0
    v_mov_b32 v21, 0
    v_mov_b32 v22, 0
    v_mov_b32 v23, 0
    v_and_b32 v30, 7, v0
    v_lshrrev_b32 v31, 4, v0
    v_xor_b32 v30, v30, v31
    v_lshlrev_b32 v6, 4, v30
    v_xor_b32 v7, 64, v6
    v_lshrrev_b32 v30, 5, v0
    v_and_b32 v31, 31, v0
    v_lshlrev_b32 v32, 1, v30
    v_xor_b32 v31, v31, v32
    v_lshlrev_b32 v31, 4, v31
    v_lshl_add_u32 v31, v30, 10, v31
    s_lshl_b32 s55, s3, 14
    s_lshl_b32 s56, s48, 9
    s_add_u32 s55, s55, s56
    v_add_u32 v31, s55, v31
    v_add_u32 v8, 0, v31
    v_xor_b32 v32, 64, v31
    v_add_u32 v9, 2048, v32
    v_add_u32 v10, 4096, v31
    v_xor_b32 v32, 64, v31
    v_add_u32 v11, 6144, v32
    v_xor_b32 v32, 128, v31
    v_add_u32 v12, 8192, v32
    v_xor_b32 v32, 192, v31
    v_add_u32 v13, 10240, v32
    v_xor_b32 v32, 128, v31
    v_add_u32 v14, 12288, v32
    v_xor_b32 v32, 192, v31
    v_add_u32 v15, 14336, v32
    v_and_b32 v31, 31, v0
    v_lshlrev_b32 v31, 4, v31
    v_lshl_add_u32 v31, v30, 10, v31
    s_lshl_b32 s55, s61, 14
    s_lshl_b32 s57, s3, 12
    s_add_u32 s55, s55, s57
    s_add_u32 s55, s55, s56
    v_add_u32 v16, s55, v31
    s_mov_b32 s54, 0
    s_and_b32 s87, s61, 1
    s_sub_u32 s88, 2, s87
    s_sub_u32 s89, 26, s87
    s_mov_b32 s63, s48
    s_lshl_b32 s59, s3, 12
    s_lshl_b32 s60, s3, 13
    s_add_u32 s60, s60, 16384
    s_mov_b32 s58, 128
    s_waitcnt lgkmcnt(0)
    s_mov_b32 s28, s4
    s_and_b32 s29, s5, 0xffff
    s_mov_b32 s30, 1703936
    s_mov_b32 s31, 0x00020000
    s_mov_b32 s32, s6
    s_and_b32 s33, s7, 0xffff
    s_mov_b32 s34, 25600000
    s_mov_b32 s35, 0x00020000
    s_mov_b32 s36, s14
    s_and_b32 s37, s15, 0xffff
    s_mov_b32 s38, 3407872
    s_mov_b32 s39, 0x00020000
    s_mov_b32 s62, 262144
    buffer_load_dwordx4 v[40:43], v5, s[28:31], 0 offen offset:0
    buffer_load_dwordx4 v[44:47], v5, s[28:31], 0 offen offset:832
    buffer_load_dwordx4 v[48:51], v5, s[28:31], 0 offen offset:1664
    buffer_load_dwordx4 v[52:55], v5, s[28:31], 0 offen offset:2496
    s_mov_b32 s53, s54
    s_lshl_b32 s53, s53, 17
    s_add_u32 s66, s60, 0
    s_add_u32 m0, s66, 0
    s_nop 0
    buffer_load_dwordx4 v8, s[36:39], s53 offen lds
    s_add_u32 m0, s66, 1024
    s_nop 0
    buffer_load_dwordx4 v9, s[36:39], s53 offen lds
    s_add_u32 m0, s66, 2048
    s_nop 0
    buffer_load_dwordx4 v10, s[36:39], s53 offen lds
    s_add_u32 m0, s66, 3072
    s_nop 0
    buffer_load_dwordx4 v11, s[36:39], s53 offen lds
    s_add_u32 m0, s66, 4096
    s_nop 0
    buffer_load_dwordx4 v12, s[36:39], s53 offen lds
    s_add_u32 m0, s66, 5120
    s_nop 0
    buffer_load_dwordx4 v13, s[36:39], s53 offen lds
    s_add_u32 m0, s66, 6144
    s_nop 0
    buffer_load_dwordx4 v14, s[36:39], s53 offen lds
    s_add_u32 m0, s66, 7168
    s_nop 0
    buffer_load_dwordx4 v15, s[36:39], s53 offen lds
    s_waitcnt vmcnt(8)
    v_mov_b32_dpp v64, v40 quad_perm:[0,0,0,0] row_mask:0xf bank_mask:0xf
    v_mov_b32_dpp v65, v44 quad_perm:[0,0,0,0] row_mask:0xf bank_mask:0xf
    v_mov_b32_dpp v66, v48 quad_perm:[0,0,0,0] row_mask:0xf bank_mask:0xf
    v_mov_b32_dpp v67, v52 quad_perm:[0,0,0,0] row_mask:0xf bank_mask:0xf
    v_mov_b32_dpp v64, v64 row_shr:4 row_mask:0xf bank_mask:0xa
    v_mov_b32_dpp v65, v65 row_shr:4 row_mask:0xf bank_mask:0xa
    v_mov_b32_dpp v66, v66 row_shr:4 row_mask:0xf bank_mask:0xa
    v_mov_b32_dpp v67, v67 row_shr:4 row_mask:0xf bank_mask:0xa
    v_lshl_add_u32 v64, v64, 8, v6
    v_lshl_add_u32 v65, v65, 8, v7
    v_lshl_add_u32 v66, v66, 8, v6
    v_lshl_add_u32 v67, v67, 8, v7
    v_mov_b32_dpp v68, v41 quad_perm:[0,0,0,0] row_mask:0xf bank_mask:0xf
    v_mov_b32_dpp v69, v45 quad_perm:[0,0,0,0] row_mask:0xf bank_mask:0xf
    v_mov_b32_dpp v70, v49 quad_perm:[0,0,0,0] row_mask:0xf bank_mask:0xf
    v_mov_b32_dpp v71, v53 quad_perm:[0,0,0,0] row_mask:0xf bank_mask:0xf
    v_mov_b32_dpp v68, v68 row_shr:4 row_mask:0xf bank_mask:0xa
    v_mov_b32_dpp v69, v69 row_shr:4 row_mask:0xf bank_mask:0xa
    v_mov_b32_dpp v70, v70 row_shr:4 row_mask:0xf bank_mask:0xa
    v_mov_b32_dpp v71, v71 row_shr:4 row_mask:0xf bank_mask:0xa
    v_lshl_add_u32 v68, v68, 8, v6
    v_lshl_add_u32 v69, v69, 8, v7
    v_lshl_add_u32 v70, v70, 8, v6
    v_lshl_add_u32 v71, v71, 8, v7
    v_mov_b32_dpp v72, v42 quad_perm:[0,0,0,0] row_mask:0xf bank_mask:0xf
    v_mov_b32_dpp v73, v46 quad_perm:[0,0,0,0] row_mask:0xf bank_mask:0xf
    v_mov_b32_dpp v74, v50 quad_perm:[0,0,0,0] row_mask:0xf bank_mask:0xf
    v_mov_b32_dpp v75, v54 quad_perm:[0,0,0,0] row_mask:0xf bank_mask:0xf
    v_mov_b32_dpp v72, v72 row_shr:4 row_mask:0xf bank_mask:0xa
    v_mov_b32_dpp v73, v73 row_shr:4 row_mask:0xf bank_mask:0xa
    v_mov_b32_dpp v74, v74 row_shr:4 row_mask:0xf bank_mask:0xa
    v_mov_b32_dpp v75, v75 row_shr:4 row_mask:0xf bank_mask:0xa
    v_lshl_add_u32 v72, v72, 8, v6
    v_lshl_add_u32 v73, v73, 8, v7
    v_lshl_add_u32 v74, v74, 8, v6
    v_lshl_add_u32 v75, v75, 8, v7
    s_sub_u32 s56, 0, s87
    s_xor_b32 s56, s56, s63
    s_add_u32 s56, s56, s87
    s_mov_b32 s86, 0
    s_cmp_ge_u32 s86, s88
    s_cselect_b32 s56, s56, s86
    s_cmp_lt_u32 s86, s89
    s_cselect_b32 s86, s56, s86
    s_lshl_b32 s56, s86, 2
    s_set_gpr_idx_on s56, gpr_idx(SRC0)
    v_mov_b32 v20, v64
    v_mov_b32 v21, v65
    v_mov_b32 v22, v66
    v_mov_b32 v23, v67
    s_set_gpr_idx_off
    s_add_u32 m0, s59, 0
    s_nop 0
    buffer_load_dwordx4 v20, s[32:35], 0 offen lds
    s_add_u32 m0, m0, 1024
    s_nop 0
    buffer_load_dwordx4 v21, s[32:35], 0 offen lds
    s_add_u32 m0, m0, 1024
    s_nop 0
    buffer_load_dwordx4 v22, s[32:35], 0 offen lds
    s_add_u32 m0, m0, 1024
    s_nop 0
    buffer_load_dwordx4 v23, s[32:35], 0 offen lds
    s_waitcnt vmcnt(12)
    v_mov_b32_dpp v76, v43 quad_perm:[0,0,0,0] row_mask:0xf bank_mask:0xf
    v_mov_b32_dpp v77, v47 quad_perm:[0,0,0,0] row_mask:0xf bank_mask:0xf
    v_mov_b32_dpp v78, v51 quad_perm:[0,0,0,0] row_mask:0xf bank_mask:0xf
    v_mov_b32_dpp v79, v55 quad_perm:[0,0,0,0] row_mask:0xf bank_mask:0xf
    v_mov_b32_dpp v76, v76 row_shr:4 row_mask:0xf bank_mask:0xa
    v_mov_b32_dpp v77, v77 row_shr:4 row_mask:0xf bank_mask:0xa
    v_mov_b32_dpp v78, v78 row_shr:4 row_mask:0xf bank_mask:0xa
    v_mov_b32_dpp v79, v79 row_shr:4 row_mask:0xf bank_mask:0xa
    v_lshl_add_u32 v76, v76, 8, v6
    v_lshl_add_u32 v77, v77, 8, v7
    v_lshl_add_u32 v78, v78, 8, v6
    v_lshl_add_u32 v79, v79, 8, v7
    v_mov_b32_dpp v80, v40 quad_perm:[1,1,1,1] row_mask:0xf bank_mask:0xf
    v_mov_b32_dpp v81, v44 quad_perm:[1,1,1,1] row_mask:0xf bank_mask:0xf
    v_mov_b32_dpp v82, v48 quad_perm:[1,1,1,1] row_mask:0xf bank_mask:0xf
    v_mov_b32_dpp v83, v52 quad_perm:[1,1,1,1] row_mask:0xf bank_mask:0xf
    v_mov_b32_dpp v80, v80 row_shr:4 row_mask:0xf bank_mask:0xa
    v_mov_b32_dpp v81, v81 row_shr:4 row_mask:0xf bank_mask:0xa
    v_mov_b32_dpp v82, v82 row_shr:4 row_mask:0xf bank_mask:0xa
    v_mov_b32_dpp v83, v83 row_shr:4 row_mask:0xf bank_mask:0xa
    v_lshl_add_u32 v80, v80, 8, v6
    v_lshl_add_u32 v81, v81, 8, v7
    v_lshl_add_u32 v82, v82, 8, v6
    v_lshl_add_u32 v83, v83, 8, v7
    v_mov_b32_dpp v84, v41 quad_perm:[1,1,1,1] row_mask:0xf bank_mask:0xf
    v_mov_b32_dpp v85, v45 quad_perm:[1,1,1,1] row_mask:0xf bank_mask:0xf
    v_mov_b32_dpp v86, v49 quad_perm:[1,1,1,1] row_mask:0xf bank_mask:0xf
    v_mov_b32_dpp v87, v53 quad_perm:[1,1,1,1] row_mask:0xf bank_mask:0xf
    v_mov_b32_dpp v84, v84 row_shr:4 row_mask:0xf bank_mask:0xa
    v_mov_b32_dpp v85, v85 row_shr:4 row_mask:0xf bank_mask:0xa
    v_mov_b32_dpp v86, v86 row_shr:4 row_mask:0xf bank_mask:0xa
    v_mov_b32_dpp v87, v87 row_shr:4 row_mask:0xf bank_mask:0xa
    v_lshl_add_u32 v84, v84, 8, v6
    v_lshl_add_u32 v85, v85, 8, v7
    v_lshl_add_u32 v86, v86, 8, v6
    v_lshl_add_u32 v87, v87, 8, v7
    v_mov_b32_dpp v88, v42 quad_perm:[1,1,1,1] row_mask:0xf bank_mask:0xf
    v_mov_b32_dpp v89, v46 quad_perm:[1,1,1,1] row_mask:0xf bank_mask:0xf
    v_mov_b32_dpp v90, v50 quad_perm:[1,1,1,1] row_mask:0xf bank_mask:0xf
    v_mov_b32_dpp v91, v54 quad_perm:[1,1,1,1] row_mask:0xf bank_mask:0xf
    v_mov_b32_dpp v88, v88 row_shr:4 row_mask:0xf bank_mask:0xa
    v_mov_b32_dpp v89, v89 row_shr:4 row_mask:0xf bank_mask:0xa
    v_mov_b32_dpp v90, v90 row_shr:4 row_mask:0xf bank_mask:0xa
    v_mov_b32_dpp v91, v91 row_shr:4 row_mask:0xf bank_mask:0xa
    v_lshl_add_u32 v88, v88, 8, v6
    v_lshl_add_u32 v89, v89, 8, v7
    v_lshl_add_u32 v90, v90, 8, v6
    v_lshl_add_u32 v91, v91, 8, v7
    v_mov_b32_dpp v92, v43 quad_perm:[1,1,1,1] row_mask:0xf bank_mask:0xf
    v_mov_b32_dpp v93, v47 quad_perm:[1,1,1,1] row_mask:0xf bank_mask:0xf
    v_mov_b32_dpp v94, v51 quad_perm:[1,1,1,1] row_mask:0xf bank_mask:0xf
    v_mov_b32_dpp v95, v55 quad_perm:[1,1,1,1] row_mask:0xf bank_mask:0xf
    v_mov_b32_dpp v92, v92 row_shr:4 row_mask:0xf bank_mask:0xa
    v_mov_b32_dpp v93, v93 row_shr:4 row_mask:0xf bank_mask:0xa
    v_mov_b32_dpp v94, v94 row_shr:4 row_mask:0xf bank_mask:0xa
    v_mov_b32_dpp v95, v95 row_shr:4 row_mask:0xf bank_mask:0xa
    v_lshl_add_u32 v92, v92, 8, v6
    v_lshl_add_u32 v93, v93, 8, v7
    v_lshl_add_u32 v94, v94, 8, v6
    v_lshl_add_u32 v95, v95, 8, v7
    v_mov_b32_dpp v96, v40 quad_perm:[2,2,2,2] row_mask:0xf bank_mask:0xf
    v_mov_b32_dpp v97, v44 quad_perm:[2,2,2,2] row_mask:0xf bank_mask:0xf
    v_mov_b32_dpp v98, v48 quad_perm:[2,2,2,2] row_mask:0xf bank_mask:0xf
    v_mov_b32_dpp v99, v52 quad_perm:[2,2,2,2] row_mask:0xf bank_mask:0xf
    v_mov_b32_dpp v96, v96 row_shr:4 row_mask:0xf bank_mask:0xa
    v_mov_b32_dpp v97, v97 row_shr:4 row_mask:0xf bank_mask:0xa
    v_mov_b32_dpp v98, v98 row_shr:4 row_mask:0xf bank_mask:0xa
    v_mov_b32_dpp v99, v99 row_shr:4 row_mask:0xf bank_mask:0xa
    v_lshl_add_u32 v96, v96, 8, v6
    v_lshl_add_u32 v97, v97, 8, v7
    v_lshl_add_u32 v98, v98, 8, v6
    v_lshl_add_u32 v99, v99, 8, v7
    v_mov_b32_dpp v100, v41 quad_perm:[2,2,2,2] row_mask:0xf bank_mask:0xf
    v_mov_b32_dpp v101, v45 quad_perm:[2,2,2,2] row_mask:0xf bank_mask:0xf
    v_mov_b32_dpp v102, v49 quad_perm:[2,2,2,2] row_mask:0xf bank_mask:0xf
    v_mov_b32_dpp v103, v53 quad_perm:[2,2,2,2] row_mask:0xf bank_mask:0xf
    v_mov_b32_dpp v100, v100 row_shr:4 row_mask:0xf bank_mask:0xa
    v_mov_b32_dpp v101, v101 row_shr:4 row_mask:0xf bank_mask:0xa
    v_mov_b32_dpp v102, v102 row_shr:4 row_mask:0xf bank_mask:0xa
    v_mov_b32_dpp v103, v103 row_shr:4 row_mask:0xf bank_mask:0xa
    v_lshl_add_u32 v100, v100, 8, v6
    v_lshl_add_u32 v101, v101, 8, v7
    v_lshl_add_u32 v102, v102, 8, v6
    v_lshl_add_u32 v103, v103, 8, v7
    v_mov_b32_dpp v104, v42 quad_perm:[2,2,2,2] row_mask:0xf bank_mask:0xf
    v_mov_b32_dpp v105, v46 quad_perm:[2,2,2,2] row_mask:0xf bank_mask:0xf
    v_mov_b32_dpp v106, v50 quad_perm:[2,2,2,2] row_mask:0xf bank_mask:0xf
    v_mov_b32_dpp v107, v54 quad_perm:[2,2,2,2] row_mask:0xf bank_mask:0xf
    v_mov_b32_dpp v104, v104 row_shr:4 row_mask:0xf bank_mask:0xa
    v_mov_b32_dpp v105, v105 row_shr:4 row_mask:0xf bank_mask:0xa
    v_mov_b32_dpp v106, v106 row_shr:4 row_mask:0xf bank_mask:0xa
    v_mov_b32_dpp v107, v107 row_shr:4 row_mask:0xf bank_mask:0xa
    v_lshl_add_u32 v104, v104, 8, v6
    v_lshl_add_u32 v105, v105, 8, v7
    v_lshl_add_u32 v106, v106, 8, v6
    v_lshl_add_u32 v107, v107, 8, v7
    v_mov_b32_dpp v108, v43 quad_perm:[2,2,2,2] row_mask:0xf bank_mask:0xf
    v_mov_b32_dpp v109, v47 quad_perm:[2,2,2,2] row_mask:0xf bank_mask:0xf
    v_mov_b32_dpp v110, v51 quad_perm:[2,2,2,2] row_mask:0xf bank_mask:0xf
    v_mov_b32_dpp v111, v55 quad_perm:[2,2,2,2] row_mask:0xf bank_mask:0xf
    v_mov_b32_dpp v108, v108 row_shr:4 row_mask:0xf bank_mask:0xa
    v_mov_b32_dpp v109, v109 row_shr:4 row_mask:0xf bank_mask:0xa
    v_mov_b32_dpp v110, v110 row_shr:4 row_mask:0xf bank_mask:0xa
    v_mov_b32_dpp v111, v111 row_shr:4 row_mask:0xf bank_mask:0xa
    v_lshl_add_u32 v108, v108, 8, v6
    v_lshl_add_u32 v109, v109, 8, v7
    v_lshl_add_u32 v110, v110, 8, v6
    v_lshl_add_u32 v111, v111, 8, v7
    v_mov_b32_dpp v112, v40 quad_perm:[3,3,3,3] row_mask:0xf bank_mask:0xf
    v_mov_b32_dpp v113, v44 quad_perm:[3,3,3,3] row_mask:0xf bank_mask:0xf
    v_mov_b32_dpp v114, v48 quad_perm:[3,3,3,3] row_mask:0xf bank_mask:0xf
    v_mov_b32_dpp v115, v52 quad_perm:[3,3,3,3] row_mask:0xf bank_mask:0xf
    v_mov_b32_dpp v112, v112 row_shr:4 row_mask:0xf bank_mask:0xa
    v_mov_b32_dpp v113, v113 row_shr:4 row_mask:0xf bank_mask:0xa
    v_mov_b32_dpp v114, v114 row_shr:4 row_mask:0xf bank_mask:0xa
    v_mov_b32_dpp v115, v115 row_shr:4 row_mask:0xf bank_mask:0xa
    v_lshl_add_u32 v112, v112, 8, v6
    v_lshl_add_u32 v113, v113, 8, v7
    v_lshl_add_u32 v114, v114, 8, v6
    v_lshl_add_u32 v115, v115, 8, v7
    v_mov_b32_dpp v116, v41 quad_perm:[3,3,3,3] row_mask:0xf bank_mask:0xf
    v_mov_b32_dpp v117, v45 quad_perm:[3,3,3,3] row_mask:0xf bank_mask:0xf
    v_mov_b32_dpp v118, v49 quad_perm:[3,3,3,3] row_mask:0xf bank_mask:0xf
    v_mov_b32_dpp v119, v53 quad_perm:[3,3,3,3] row_mask:0xf bank_mask:0xf
    v_mov_b32_dpp v116, v116 row_shr:4 row_mask:0xf bank_mask:0xa
    v_mov_b32_dpp v117, v117 row_shr:4 row_mask:0xf bank_mask:0xa
    v_mov_b32_dpp v118, v118 row_shr:4 row_mask:0xf bank_mask:0xa
    v_mov_b32_dpp v119, v119 row_shr:4 row_mask:0xf bank_mask:0xa
    v_lshl_add_u32 v116, v116, 8, v6
    v_lshl_add_u32 v117, v117, 8, v7
    v_lshl_add_u32 v118, v118, 8, v6
    v_lshl_add_u32 v119, v119, 8, v7
    s_add_u32 m0, s59, 49152
    s_nop 0
    buffer_load_dwordx4 v20, s[32:35], s58 offen lds
    s_add_u32 m0, m0, 1024
    s_nop 0
    buffer_load_dwordx4 v21, s[32:35], s58 offen lds
    s_add_u32 m0, m0, 1024
    s_nop 0
    buffer_load_dwordx4 v22, s[32:35], s58 offen lds
    s_add_u32 m0, m0, 1024
    s_nop 0
    buffer_load_dwordx4 v23, s[32:35], s58 offen lds
    s_mov_b32 s53, s54
    s_lshl_b32 s53, s53, 17
    s_add_u32 s53, s53, 65536
    s_add_u32 s66, s60, 49152
    s_add_u32 m0, s66, 0
    s_nop 0
    buffer_load_dwordx4 v8, s[36:39], s53 offen lds
    s_add_u32 m0, s66, 1024
    s_nop 0
    buffer_load_dwordx4 v9, s[36:39], s53 offen lds
    s_add_u32 m0, s66, 2048
    s_nop 0
    buffer_load_dwordx4 v10, s[36:39], s53 offen lds
    s_add_u32 m0, s66, 3072
    s_nop 0
    buffer_load_dwordx4 v11, s[36:39], s53 offen lds
    s_add_u32 m0, s66, 4096
    s_nop 0
    buffer_load_dwordx4 v12, s[36:39], s53 offen lds
    s_add_u32 m0, s66, 5120
    s_nop 0
    buffer_load_dwordx4 v13, s[36:39], s53 offen lds
    s_add_u32 m0, s66, 6144
    s_nop 0
    buffer_load_dwordx4 v14, s[36:39], s53 offen lds
    s_add_u32 m0, s66, 7168
    s_nop 0
    buffer_load_dwordx4 v15, s[36:39], s53 offen lds
    s_sub_u32 s56, 1, s87
    s_xor_b32 s56, s56, s63
    s_add_u32 s56, s56, s87
    s_mov_b32 s86, 1
    s_cmp_ge_u32 s86, s88
    s_cselect_b32 s56, s56, s86
    s_cmp_lt_u32 s86, s89
    s_cselect_b32 s86, s56, s86
    s_lshl_b32 s56, s86, 2
    s_set_gpr_idx_on s56, gpr_idx(SRC0)
    v_mov_b32 v20, v64
    v_mov_b32 v21, v65
    v_mov_b32 v22, v66
    v_mov_b32 v23, v67
    s_set_gpr_idx_off
    s_add_u32 m0, s59, 98304
    s_nop 0
    buffer_load_dwordx4 v20, s[32:35], 0 offen lds
    s_add_u32 m0, m0, 1024
    s_nop 0
    buffer_load_dwordx4 v21, s[32:35], 0 offen lds
    s_add_u32 m0, m0, 1024
    s_nop 0
    buffer_load_dwordx4 v22, s[32:35], 0 offen lds
    s_add_u32 m0, m0, 1024
    s_nop 0
    buffer_load_dwordx4 v23, s[32:35], 0 offen lds
    s_mov_b32 s54, s86
    s_mov_b32 s53, s54
    s_lshl_b32 s53, s53, 17
    s_add_u32 s66, s60, 98304
    s_add_u32 m0, s66, 0
    s_nop 0
    buffer_load_dwordx4 v8, s[36:39], s53 offen lds
    s_add_u32 m0, s66, 1024
    s_nop 0
    buffer_load_dwordx4 v9, s[36:39], s53 offen lds
    s_add_u32 m0, s66, 2048
    s_nop 0
    buffer_load_dwordx4 v10, s[36:39], s53 offen lds
    s_add_u32 m0, s66, 3072
    s_nop 0
    buffer_load_dwordx4 v11, s[36:39], s53 offen lds
    s_add_u32 m0, s66, 4096
    s_nop 0
    buffer_load_dwordx4 v12, s[36:39], s53 offen lds
    s_add_u32 m0, s66, 5120
    s_nop 0
    buffer_load_dwordx4 v13, s[36:39], s53 offen lds
    s_add_u32 m0, s66, 6144
    s_nop 0
    buffer_load_dwordx4 v14, s[36:39], s53 offen lds
    s_add_u32 m0, s66, 7168
    s_nop 0
    buffer_load_dwordx4 v15, s[36:39], s53 offen lds
    s_waitcnt vmcnt(24)
    s_barrier
    v_mov_b32_dpp v120, v42 quad_perm:[3,3,3,3] row_mask:0xf bank_mask:0xf
    v_mov_b32_dpp v121, v46 quad_perm:[3,3,3,3] row_mask:0xf bank_mask:0xf
    v_mov_b32_dpp v122, v50 quad_perm:[3,3,3,3] row_mask:0xf bank_mask:0xf
    v_mov_b32_dpp v123, v54 quad_perm:[3,3,3,3] row_mask:0xf bank_mask:0xf
    v_mov_b32_dpp v120, v120 row_shr:4 row_mask:0xf bank_mask:0xa
    v_mov_b32_dpp v121, v121 row_shr:4 row_mask:0xf bank_mask:0xa
    v_mov_b32_dpp v122, v122 row_shr:4 row_mask:0xf bank_mask:0xa
    v_mov_b32_dpp v123, v123 row_shr:4 row_mask:0xf bank_mask:0xa
    v_lshl_add_u32 v120, v120, 8, v6
    v_lshl_add_u32 v121, v121, 8, v7
    v_lshl_add_u32 v122, v122, 8, v6
    v_lshl_add_u32 v123, v123, 8, v7
    v_mov_b32_dpp v124, v43 quad_perm:[3,3,3,3] row_mask:0xf bank_mask:0xf
    v_mov_b32_dpp v125, v47 quad_perm:[3,3,3,3] row_mask:0xf bank_mask:0xf
    v_mov_b32_dpp v126, v51 quad_perm:[3,3,3,3] row_mask:0xf bank_mask:0xf
    v_mov_b32_dpp v127, v55 quad_perm:[3,3,3,3] row_mask:0xf bank_mask:0xf
    v_mov_b32_dpp v124, v124 row_shr:4 row_mask:0xf bank_mask:0xa
    v_mov_b32_dpp v125, v125 row_shr:4 row_mask:0xf bank_mask:0xa
    v_mov_b32_dpp v126, v126 row_shr:4 row_mask:0xf bank_mask:0xa
    v_mov_b32_dpp v127, v127 row_shr:4 row_mask:0xf bank_mask:0xa
    v_lshl_add_u32 v124, v124, 8, v6
    v_lshl_add_u32 v125, v125, 8, v7
    v_lshl_add_u32 v126, v126, 8, v6
    v_lshl_add_u32 v127, v127, 8, v7
    v_mov_b32_dpp v128, v40 quad_perm:[0,0,0,0] row_mask:0xf bank_mask:0xf
    v_mov_b32_dpp v129, v44 quad_perm:[0,0,0,0] row_mask:0xf bank_mask:0xf
    v_mov_b32_dpp v130, v48 quad_perm:[0,0,0,0] row_mask:0xf bank_mask:0xf
    v_mov_b32_dpp v131, v52 quad_perm:[0,0,0,0] row_mask:0xf bank_mask:0xf
    v_mov_b32_dpp v128, v128 row_shl:4 row_mask:0xf bank_mask:0x5
    v_mov_b32_dpp v129, v129 row_shl:4 row_mask:0xf bank_mask:0x5
    v_mov_b32_dpp v130, v130 row_shl:4 row_mask:0xf bank_mask:0x5
    v_mov_b32_dpp v131, v131 row_shl:4 row_mask:0xf bank_mask:0x5
    v_lshl_add_u32 v128, v128, 8, v6
    v_lshl_add_u32 v129, v129, 8, v7
    v_lshl_add_u32 v130, v130, 8, v6
    v_lshl_add_u32 v131, v131, 8, v7
    v_mov_b32_dpp v132, v41 quad_perm:[0,0,0,0] row_mask:0xf bank_mask:0xf
    v_mov_b32_dpp v133, v45 quad_perm:[0,0,0,0] row_mask:0xf bank_mask:0xf
    v_mov_b32_dpp v134, v49 quad_perm:[0,0,0,0] row_mask:0xf bank_mask:0xf
    v_mov_b32_dpp v135, v53 quad_perm:[0,0,0,0] row_mask:0xf bank_mask:0xf
    v_mov_b32_dpp v132, v132 row_shl:4 row_mask:0xf bank_mask:0x5
    v_mov_b32_dpp v133, v133 row_shl:4 row_mask:0xf bank_mask:0x5
    v_mov_b32_dpp v134, v134 row_shl:4 row_mask:0xf bank_mask:0x5
    v_mov_b32_dpp v135, v135 row_shl:4 row_mask:0xf bank_mask:0x5
    v_lshl_add_u32 v132, v132, 8, v6
    v_lshl_add_u32 v133, v133, 8, v7
    v_lshl_add_u32 v134, v134, 8, v6
    v_lshl_add_u32 v135, v135, 8, v7
    v_mov_b32_dpp v136, v42 quad_perm:[0,0,0,0] row_mask:0xf bank_mask:0xf
    v_mov_b32_dpp v137, v46 quad_perm:[0,0,0,0] row_mask:0xf bank_mask:0xf
    v_mov_b32_dpp v138, v50 quad_perm:[0,0,0,0] row_mask:0xf bank_mask:0xf
    v_mov_b32_dpp v139, v54 quad_perm:[0,0,0,0] row_mask:0xf bank_mask:0xf
    v_mov_b32_dpp v136, v136 row_shl:4 row_mask:0xf bank_mask:0x5
    v_mov_b32_dpp v137, v137 row_shl:4 row_mask:0xf bank_mask:0x5
    v_mov_b32_dpp v138, v138 row_shl:4 row_mask:0xf bank_mask:0x5
    v_mov_b32_dpp v139, v139 row_shl:4 row_mask:0xf bank_mask:0x5
    v_lshl_add_u32 v136, v136, 8, v6
    v_lshl_add_u32 v137, v137, 8, v7
    v_lshl_add_u32 v138, v138, 8, v6
    v_lshl_add_u32 v139, v139, 8, v7
    v_mov_b32_dpp v140, v43 quad_perm:[0,0,0,0] row_mask:0xf bank_mask:0xf
    v_mov_b32_dpp v141, v47 quad_perm:[0,0,0,0] row_mask:0xf bank_mask:0xf
    v_mov_b32_dpp v142, v51 quad_perm:[0,0,0,0] row_mask:0xf bank_mask:0xf
    v_mov_b32_dpp v143, v55 quad_perm:[0,0,0,0] row_mask:0xf bank_mask:0xf
    v_mov_b32_dpp v140, v140 row_shl:4 row_mask:0xf bank_mask:0x5
    v_mov_b32_dpp v141, v141 row_shl:4 row_mask:0xf bank_mask:0x5
    v_mov_b32_dpp v142, v142 row_shl:4 row_mask:0xf bank_mask:0x5
    v_mov_b32_dpp v143, v143 row_shl:4 row_mask:0xf bank_mask:0x5
    v_lshl_add_u32 v140, v140, 8, v6
    v_lshl_add_u32 v141, v141, 8, v7
    v_lshl_add_u32 v142, v142, 8, v6
    v_lshl_add_u32 v143, v143, 8, v7
    v_mov_b32_dpp v144, v40 quad_perm:[1,1,1,1] row_mask:0xf bank_mask:0xf
    v_mov_b32_dpp v145, v44 quad_perm:[1,1,1,1] row_mask:0xf bank_mask:0xf
    v_mov_b32_dpp v146, v48 quad_perm:[1,1,1,1] row_mask:0xf bank_mask:0xf
    v_mov_b32_dpp v147, v52 quad_perm:[1,1,1,1] row_mask:0xf bank_mask:0xf
    v_mov_b32_dpp v144, v144 row_shl:4 row_mask:0xf bank_mask:0x5
    v_mov_b32_dpp v145, v145 row_shl:4 row_mask:0xf bank_mask:0x5
    v_mov_b32_dpp v146, v146 row_shl:4 row_mask:0xf bank_mask:0x5
    v_mov_b32_dpp v147, v147 row_shl:4 row_mask:0xf bank_mask:0x5
    v_lshl_add_u32 v144, v144, 8, v6
    v_lshl_add_u32 v145, v145, 8, v7
    v_lshl_add_u32 v146, v146, 8, v6
    v_lshl_add_u32 v147, v147, 8, v7
    v_mov_b32_dpp v148, v41 quad_perm:[1,1,1,1] row_mask:0xf bank_mask:0xf
    v_mov_b32_dpp v149, v45 quad_perm:[1,1,1,1] row_mask:0xf bank_mask:0xf
    v_mov_b32_dpp v150, v49 quad_perm:[1,1,1,1] row_mask:0xf bank_mask:0xf
    v_mov_b32_dpp v151, v53 quad_perm:[1,1,1,1] row_mask:0xf bank_mask:0xf
    v_mov_b32_dpp v148, v148 row_shl:4 row_mask:0xf bank_mask:0x5
    v_mov_b32_dpp v149, v149 row_shl:4 row_mask:0xf bank_mask:0x5
    v_mov_b32_dpp v150, v150 row_shl:4 row_mask:0xf bank_mask:0x5
    v_mov_b32_dpp v151, v151 row_shl:4 row_mask:0xf bank_mask:0x5
    v_lshl_add_u32 v148, v148, 8, v6
    v_lshl_add_u32 v149, v149, 8, v7
    v_lshl_add_u32 v150, v150, 8, v6
    v_lshl_add_u32 v151, v151, 8, v7
    v_mov_b32_dpp v152, v42 quad_perm:[1,1,1,1] row_mask:0xf bank_mask:0xf
    v_mov_b32_dpp v153, v46 quad_perm:[1,1,1,1] row_mask:0xf bank_mask:0xf
    v_mov_b32_dpp v154, v50 quad_perm:[1,1,1,1] row_mask:0xf bank_mask:0xf
    v_mov_b32_dpp v155, v54 quad_perm:[1,1,1,1] row_mask:0xf bank_mask:0xf
    v_mov_b32_dpp v152, v152 row_shl:4 row_mask:0xf bank_mask:0x5
    v_mov_b32_dpp v153, v153 row_shl:4 row_mask:0xf bank_mask:0x5
    v_mov_b32_dpp v154, v154 row_shl:4 row_mask:0xf bank_mask:0x5
    v_mov_b32_dpp v155, v155 row_shl:4 row_mask:0xf bank_mask:0x5
    v_lshl_add_u32 v152, v152, 8, v6
    v_lshl_add_u32 v153, v153, 8, v7
    v_lshl_add_u32 v154, v154, 8, v6
    v_lshl_add_u32 v155, v155, 8, v7
    v_mov_b32_dpp v156, v43 quad_perm:[1,1,1,1] row_mask:0xf bank_mask:0xf
    v_mov_b32_dpp v157, v47 quad_perm:[1,1,1,1] row_mask:0xf bank_mask:0xf
    v_mov_b32_dpp v158, v51 quad_perm:[1,1,1,1] row_mask:0xf bank_mask:0xf
    v_mov_b32_dpp v159, v55 quad_perm:[1,1,1,1] row_mask:0xf bank_mask:0xf
    v_mov_b32_dpp v156, v156 row_shl:4 row_mask:0xf bank_mask:0x5
    v_mov_b32_dpp v157, v157 row_shl:4 row_mask:0xf bank_mask:0x5
    v_mov_b32_dpp v158, v158 row_shl:4 row_mask:0xf bank_mask:0x5
    v_mov_b32_dpp v159, v159 row_shl:4 row_mask:0xf bank_mask:0x5
    v_lshl_add_u32 v156, v156, 8, v6
    v_lshl_add_u32 v157, v157, 8, v7
    v_lshl_add_u32 v158, v158, 8, v6
    v_lshl_add_u32 v159, v159, 8, v7
    v_mov_b32_dpp v160, v40 quad_perm:[2,2,2,2] row_mask:0xf bank_mask:0xf
    v_mov_b32_dpp v161, v44 quad_perm:[2,2,2,2] row_mask:0xf bank_mask:0xf
    v_mov_b32_dpp v162, v48 quad_perm:[2,2,2,2] row_mask:0xf bank_mask:0xf
    v_mov_b32_dpp v163, v52 quad_perm:[2,2,2,2] row_mask:0xf bank_mask:0xf
    v_mov_b32_dpp v160, v160 row_shl:4 row_mask:0xf bank_mask:0x5
    v_mov_b32_dpp v161, v161 row_shl:4 row_mask:0xf bank_mask:0x5
    v_mov_b32_dpp v162, v162 row_shl:4 row_mask:0xf bank_mask:0x5
    v_mov_b32_dpp v163, v163 row_shl:4 row_mask:0xf bank_mask:0x5
    v_lshl_add_u32 v160, v160, 8, v6
    v_lshl_add_u32 v161, v161, 8, v7
    v_lshl_add_u32 v162, v162, 8, v6
    v_lshl_add_u32 v163, v163, 8, v7
    v_mov_b32_dpp v164, v41 quad_perm:[2,2,2,2] row_mask:0xf bank_mask:0xf
    v_mov_b32_dpp v165, v45 quad_perm:[2,2,2,2] row_mask:0xf bank_mask:0xf
    v_mov_b32_dpp v166, v49 quad_perm:[2,2,2,2] row_mask:0xf bank_mask:0xf
    v_mov_b32_dpp v167, v53 quad_perm:[2,2,2,2] row_mask:0xf bank_mask:0xf
    v_mov_b32_dpp v164, v164 row_shl:4 row_mask:0xf bank_mask:0x5
    v_mov_b32_dpp v165, v165 row_shl:4 row_mask:0xf bank_mask:0x5
    v_mov_b32_dpp v166, v166 row_shl:4 row_mask:0xf bank_mask:0x5
    v_mov_b32_dpp v167, v167 row_shl:4 row_mask:0xf bank_mask:0x5
    v_lshl_add_u32 v164, v164, 8, v6
    v_lshl_add_u32 v165, v165, 8, v7
    v_lshl_add_u32 v166, v166, 8, v6
    v_lshl_add_u32 v167, v167, 8, v7
    s_waitcnt vmcnt(12)
    s_barrier
    s_add_u32 m0, s59, 0
    s_nop 0
    buffer_load_dwordx4 v20, s[32:35], s58 offen lds
    s_add_u32 m0, m0, 1024
    s_nop 0
    buffer_load_dwordx4 v21, s[32:35], s58 offen lds
    s_add_u32 m0, m0, 1024
    s_nop 0
    buffer_load_dwordx4 v22, s[32:35], s58 offen lds
    s_add_u32 m0, m0, 1024
    s_nop 0
    buffer_load_dwordx4 v23, s[32:35], s58 offen lds
    s_mov_b32 s53, s54
    s_lshl_b32 s53, s53, 17
    s_add_u32 s53, s53, 65536
    s_add_u32 s66, s60, 0
    s_add_u32 m0, s66, 0
    s_nop 0
    buffer_load_dwordx4 v8, s[36:39], s53 offen lds
    s_sub_u32 s56, 2, s87
    s_xor_b32 s56, s56, s63
    s_add_u32 s56, s56, s87
    s_mov_b32 s86, 2
    s_cmp_ge_u32 s86, s88
    s_cselect_b32 s56, s56, s86
    s_cmp_lt_u32 s86, s89
    s_cselect_b32 s86, s56, s86
    s_lshl_b32 s56, s86, 2
    s_set_gpr_idx_on s56, gpr_idx(SRC0)
    v_mov_b32 v20, v64
    v_mov_b32 v21, v65
    v_mov_b32 v22, v66
    v_mov_b32 v23, v67
    s_set_gpr_idx_off
    s_add_u32 m0, s66, 1024
    s_nop 0
    buffer_load_dwordx4 v9, s[36:39], s53 offen lds
    s_add_u32 m0, s66, 2048
    s_nop 0
    buffer_load_dwordx4 v10, s[36:39], s53 offen lds
    s_add_u32 m0, s66, 3072
    s_nop 0
    buffer_load_dwordx4 v11, s[36:39], s53 offen lds
    s_add_u32 m0, s66, 4096
    s_nop 0
    buffer_load_dwordx4 v12, s[36:39], s53 offen lds
    s_add_u32 m0, s66, 5120
    s_nop 0
    buffer_load_dwordx4 v13, s[36:39], s53 offen lds
    s_add_u32 m0, s66, 6144
    s_nop 0
    buffer_load_dwordx4 v14, s[36:39], s53 offen lds
    s_add_u32 m0, s66, 7168
    s_nop 0
    buffer_load_dwordx4 v15, s[36:39], s53 offen lds
    s_waitcnt vmcnt(12)
    s_barrier
    s_mov_b32 s51, 49152
    s_mov_b32 s64, 2
    .p2align 6
L_l_loop:
    s_add_u32 m0, s59, s51
    s_nop 0
    buffer_load_dwordx4 v20, s[32:35], 0 offen lds
    s_add_u32 m0, m0, 1024
    s_nop 0
    buffer_load_dwordx4 v21, s[32:35], 0 offen lds
    s_add_u32 m0, m0, 1024
    s_nop 0
    buffer_load_dwordx4 v22, s[32:35], 0 offen lds
    s_add_u32 m0, m0, 1024
    s_nop 0
    buffer_load_dwordx4 v23, s[32:35], 0 offen lds
    s_mov_b32 s54, s86
    s_mov_b32 s53, s54
    s_lshl_b32 s53, s53, 17
    s_add_u32 s66, s60, s51
    s_add_u32 m0, s66, 0
    s_nop 0
    buffer_load_dwordx4 v8, s[36:39], s53 offen lds
    s_add_u32 m0, s66, 1024
    s_nop 0
    buffer_load_dwordx4 v9, s[36:39], s53 offen lds
    s_add_u32 m0, s66, 2048
    s_nop 0
    buffer_load_dwordx4 v10, s[36:39], s53 offen lds
    s_add_u32 m0, s66, 3072
    s_nop 0
    buffer_load_dwordx4 v11, s[36:39], s53 offen lds
    s_add_u32 m0, s66, 4096
    s_nop 0
    buffer_load_dwordx4 v12, s[36:39], s53 offen lds
    s_add_u32 m0, s66, 5120
    s_nop 0
    buffer_load_dwordx4 v13, s[36:39], s53 offen lds
    s_add_u32 m0, s66, 6144
    s_nop 0
    buffer_load_dwordx4 v14, s[36:39], s53 offen lds
    s_add_u32 m0, s66, 7168
    s_nop 0
    buffer_load_dwordx4 v15, s[36:39], s53 offen lds
    s_add_u32 s51, s51, 49152
    s_cmp_eq_u32 s51, 147456
    s_cselect_b32 s51, 0, s51
    s_waitcnt vmcnt(12)
    s_barrier
    s_add_u32 m0, s59, s51
    s_nop 0
    buffer_load_dwordx4 v20, s[32:35], s58 offen lds
    s_add_u32 m0, m0, 1024
    s_nop 0
    buffer_load_dwordx4 v21, s[32:35], s58 offen lds
    s_add_u32 m0, m0, 1024
    s_nop 0
    buffer_load_dwordx4 v22, s[32:35], s58 offen lds
    s_add_u32 m0, m0, 1024
    s_nop 0
    buffer_load_dwordx4 v23, s[32:35], s58 offen lds
    s_add_u32 s65, s64, 1
    s_mov_b32 s53, s54
    s_lshl_b32 s53, s53, 17
    s_add_u32 s53, s53, 65536
    s_add_u32 s66, s60, s51
    s_add_u32 m0, s66, 0
    s_nop 0
    buffer_load_dwordx4 v8, s[36:39], s53 offen lds
    s_sub_u32 s56, s65, s87
    s_xor_b32 s56, s56, s63
    s_add_u32 s56, s56, s87
    s_mov_b32 s86, s65
    s_cmp_ge_u32 s86, s88
    s_cselect_b32 s56, s56, s86
    s_cmp_lt_u32 s86, s89
    s_cselect_b32 s86, s56, s86
    s_lshl_b32 s56, s86, 2
    s_set_gpr_idx_on s56, gpr_idx(SRC0)
    v_mov_b32 v20, v64
    v_mov_b32 v21, v65
    v_mov_b32 v22, v66
    v_mov_b32 v23, v67
    s_set_gpr_idx_off
    s_add_u32 m0, s66, 1024
    s_nop 0
    buffer_load_dwordx4 v9, s[36:39], s53 offen lds
    s_add_u32 m0, s66, 2048
    s_nop 0
    buffer_load_dwordx4 v10, s[36:39], s53 offen lds
    s_add_u32 m0, s66, 3072
    s_nop 0
    buffer_load_dwordx4 v11, s[36:39], s53 offen lds
    s_add_u32 m0, s66, 4096
    s_nop 0
    buffer_load_dwordx4 v12, s[36:39], s53 offen lds
    s_add_u32 m0, s66, 5120
    s_nop 0
    buffer_load_dwordx4 v13, s[36:39], s53 offen lds
    s_add_u32 m0, s66, 6144
    s_nop 0
    buffer_load_dwordx4 v14, s[36:39], s53 offen lds
    s_add_u32 m0, s66, 7168
    s_nop 0
    buffer_load_dwordx4 v15, s[36:39], s53 offen lds
    s_add_u32 s51, s51, 49152
    s_cmp_eq_u32 s51, 147456
    s_cselect_b32 s51, 0, s51
    s_add_u32 s64, s64, 1
    s_waitcnt vmcnt(12)
    s_barrier
    s_add_u32 m0, s59, s51
    s_nop 0
    buffer_load_dwordx4 v20, s[32:35], 0 offen lds
    s_add_u32 m0, m0, 1024
    s_nop 0
    buffer_load_dwordx4 v21, s[32:35], 0 offen lds
    s_add_u32 m0, m0, 1024
    s_nop 0
    buffer_load_dwordx4 v22, s[32:35], 0 offen lds
    s_add_u32 m0, m0, 1024
    s_nop 0
    buffer_load_dwordx4 v23, s[32:35], 0 offen lds
    s_mov_b32 s54, s86
    s_mov_b32 s53, s54
    s_lshl_b32 s53, s53, 17
    s_add_u32 s66, s60, s51
    s_add_u32 m0, s66, 0
    s_nop 0
    buffer_load_dwordx4 v8, s[36:39], s53 offen lds
    s_add_u32 m0, s66, 1024
    s_nop 0
    buffer_load_dwordx4 v9, s[36:39], s53 offen lds
    s_add_u32 m0, s66, 2048
    s_nop 0
    buffer_load_dwordx4 v10, s[36:39], s53 offen lds
    s_add_u32 m0, s66, 3072
    s_nop 0
    buffer_load_dwordx4 v11, s[36:39], s53 offen lds
    s_add_u32 m0, s66, 4096
    s_nop 0
    buffer_load_dwordx4 v12, s[36:39], s53 offen lds
    s_add_u32 m0, s66, 5120
    s_nop 0
    buffer_load_dwordx4 v13, s[36:39], s53 offen lds
    s_add_u32 m0, s66, 6144
    s_nop 0
    buffer_load_dwordx4 v14, s[36:39], s53 offen lds
    s_add_u32 m0, s66, 7168
    s_nop 0
    buffer_load_dwordx4 v15, s[36:39], s53 offen lds
    s_add_u32 s51, s51, 49152
    s_cmp_eq_u32 s51, 147456
    s_cselect_b32 s51, 0, s51
    s_waitcnt vmcnt(12)
    s_barrier
    s_add_u32 m0, s59, s51
    s_nop 0
    buffer_load_dwordx4 v20, s[32:35], s58 offen lds
    s_add_u32 m0, m0, 1024
    s_nop 0
    buffer_load_dwordx4 v21, s[32:35], s58 offen lds
    s_add_u32 m0, m0, 1024
    s_nop 0
    buffer_load_dwordx4 v22, s[32:35], s58 offen lds
    s_add_u32 m0, m0, 1024
    s_nop 0
    buffer_load_dwordx4 v23, s[32:35], s58 offen lds
    s_add_u32 s65, s64, 1
    s_mov_b32 s53, s54
    s_lshl_b32 s53, s53, 17
    s_add_u32 s53, s53, 65536
    s_add_u32 s66, s60, s51
    s_add_u32 m0, s66, 0
    s_nop 0
    buffer_load_dwordx4 v8, s[36:39], s53 offen lds
    s_sub_u32 s56, s65, s87
    s_xor_b32 s56, s56, s63
    s_add_u32 s56, s56, s87
    s_mov_b32 s86, s65
    s_cmp_ge_u32 s86, s88
    s_cselect_b32 s56, s56, s86
    s_cmp_lt_u32 s86, s89
    s_cselect_b32 s86, s56, s86
    s_lshl_b32 s56, s86, 2
    s_set_gpr_idx_on s56, gpr_idx(SRC0)
    v_mov_b32 v20, v64
    v_mov_b32 v21, v65
    v_mov_b32 v22, v66
    v_mov_b32 v23, v67
    s_set_gpr_idx_off
    s_add_u32 m0, s66, 1024
    s_nop 0
    buffer_load_dwordx4 v9, s[36:39], s53 offen lds
    s_add_u32 m0, s66, 2048
    s_nop 0
    buffer_load_dwordx4 v10, s[36:39], s53 offen lds
    s_add_u32 m0, s66, 3072
    s_nop 0
    buffer_load_dwordx4 v11, s[36:39], s53 offen lds
    s_add_u32 m0, s66, 4096
    s_nop 0
    buffer_load_dwordx4 v12, s[36:39], s53 offen lds
    s_add_u32 m0, s66, 5120
    s_nop 0
    buffer_load_dwordx4 v13, s[36:39], s53 offen lds
    s_add_u32 m0, s66, 6144
    s_nop 0
    buffer_load_dwordx4 v14, s[36:39], s53 offen lds
    s_add_u32 m0, s66, 7168
    s_nop 0
    buffer_load_dwordx4 v15, s[36:39], s53 offen lds
    s_add_u32 s51, s51, 49152
    s_cmp_eq_u32 s51, 147456
    s_cselect_b32 s51, 0, s51
    s_add_u32 s64, s64, 1
    s_waitcnt vmcnt(12)
    s_barrier
    s_cmp_lg_u32 s64, 26
    s_cbranch_scc1 L_l_loop
    s_cmp_eq_u32 s3, 0
    s_cbranch_scc1 L_fin
    s_waitcnt vmcnt(0)
    s_barrier
    s_endpgm
L_fin:
    s_mov_b32 s40, s26
    s_and_b32 s41, s27, 0xffff
    s_mov_b32 s42, 262144
    s_mov_b32 s43, 0x00020000
    s_lshl_b32 s55, s49, 1
    s_add_u32 s69, s55, s48
    s_lshl_b32 s69, s69, 10
    v_lshlrev_b32 v14, 4, v0
    v_mov_b32 v52, 0
    v_mov_b32 v53, 0
    v_mov_b32 v54, 0
    v_mov_b32 v55, 0
    buffer_store_dwordx4 v[52:55], v14, s[40:43], s69 offen sc1
    s_mov_b32 s28, s8
    s_and_b32 s29, s9, 0xffff
    s_mov_b32 s30, 425984
    s_mov_b32 s31, 0x00020000
    v_lshl_add_u32 v14, v0, 1, s50
    v_mul_u32_u24 v14, 26, v14
    buffer_load_dwordx4 v[16:19], v14, s[28:31], 0 offen
    buffer_load_dwordx4 v[20:23], v14, s[28:31], 0 offen offset:16
    buffer_load_dwordx4 v[24:27], v14, s[28:31], 0 offen offset:32
    buffer_load_dword v28, v14, s[28:31], 0 offen offset:48
    s_mov_b32 s44, s10
    s_and_b32 s45, s11, 0xffff
    s_mov_b32 s46, 26
    s_mov_b32 s47, 0x00020000
    v_mov_b32 v15, 0
    buffer_load_ushort v32, v15, s[44:47], 0 offen offset:0
    buffer_load_ushort v33, v15, s[44:47], 0 offen offset:2
    buffer_load_ushort v34, v15, s[44:47], 0 offen offset:4
    buffer_load_ushort v35, v15, s[44:47], 0 offen offset:6
    buffer_load_ushort v36, v15, s[44:47], 0 offen offset:8
    buffer_load_ushort v37, v15, s[44:47], 0 offen offset:10
    buffer_load_ushort v38, v15, s[44:47], 0 offen offset:12
    buffer_load_ushort v39, v15, s[44:47], 0 offen offset:14
    buffer_load_ushort v40, v15, s[44:47], 0 offen offset:16
    buffer_load_ushort v41, v15, s[44:47], 0 offen offset:18
    buffer_load_ushort v42, v15, s[44:47], 0 offen offset:20
    buffer_load_ushort v43, v15, s[44:47], 0 offen offset:22
    buffer_load_ushort v44, v15, s[44:47], 0 offen offset:24
    s_mov_b32 s32, s12
    s_and_b32 s33, s13, 0xffff
    s_mov_b32 s34, 2
    s_mov_b32 s35, 0x00020000
    buffer_load_ushort v45, v15, s[32:35], 0 offen
    s_mov_b32 s36, s20
    s_and_b32 s37, s21, 0xffff
    s_mov_b32 s38, 2
    s_mov_b32 s39, 0x00020000
    buffer_load_ushort v46, v15, s[36:39], 0 offen
    s_waitcnt vmcnt(20)
    s_barrier
    s_mov_b32 s44, s24
    s_and_b32 s45, s25, 0xffff
    s_mov_b32 s46, 256
    s_mov_b32 s47, 0x00020000
    s_lshr_b32 s55, s49, 1
    s_lshl_b32 s55, s55, 2
    s_and_b32 s56, s49, 1
    s_lshl_b32 s56, s56, 4
    s_lshl_b32 s57, 1, s56
    v_mov_b32 v56, s57
    v_mov_b32 v57, s55
    s_waitcnt vmcnt(19)
    s_mov_b64 exec, 1
    buffer_atomic_add v56, v57, s[44:47], 0 offen sc0
    s_mov_b64 exec, -1
    s_waitcnt vmcnt(1)
    v_lshlrev_b32 v32, 16, v32
    v_lshlrev_b32 v33, 16, v33
    v_lshlrev_b32 v34, 16, v34
    v_lshlrev_b32 v35, 16, v35
    v_lshlrev_b32 v36, 16, v36
    v_lshlrev_b32 v37, 16, v37
    v_lshlrev_b32 v38, 16, v38
    v_lshlrev_b32 v39, 16, v39
    v_lshlrev_b32 v40, 16, v40
    v_lshlrev_b32 v41, 16, v41
    v_lshlrev_b32 v42, 16, v42
    v_lshlrev_b32 v43, 16, v43
    v_lshlrev_b32 v44, 16, v44
    v_lshlrev_b32 v45, 16, v45
    v_lshlrev_b32 v1, 16, v46
    v_lshlrev_b32 v48, 16, v16
    v_mul_f32 v50, v48, v32
    v_and_b32 v48, 0xffff0000, v16
    v_fmac_f32 v50, v48, v33
    v_lshlrev_b32 v48, 16, v17
    v_fmac_f32 v50, v48, v34
    v_and_b32 v48, 0xffff0000, v17
    v_fmac_f32 v50, v48, v35
    v_lshlrev_b32 v48, 16, v18
    v_fmac_f32 v50, v48, v36
    v_and_b32 v48, 0xffff0000, v18
    v_fmac_f32 v50, v48, v37
    v_lshlrev_b32 v48, 16, v19
    v_fmac_f32 v50, v48, v38
    v_and_b32 v48, 0xffff0000, v19
    v_fmac_f32 v50, v48, v39
    v_lshlrev_b32 v48, 16, v20
    v_fmac_f32 v50, v48, v40
    v_and_b32 v48, 0xffff0000, v20
    v_fmac_f32 v50, v48, v41
    v_lshlrev_b32 v48, 16, v21
    v_fmac_f32 v50, v48, v42
    v_and_b32 v48, 0xffff0000, v21
    v_fmac_f32 v50, v48, v43
    v_lshlrev_b32 v48, 16, v22
    v_fmac_f32 v50, v48, v44
    v_and_b32 v48, 0xffff0000, v22
    v_mul_f32 v51, v48, v32
    v_lshlrev_b32 v48, 16, v23
    v_fmac_f32 v51, v48, v33
    v_and_b32 v48, 0xffff0000, v23
    v_fmac_f32 v51, v48, v34
    v_lshlrev_b32 v48, 16, v24
    v_fmac_f32 v51, v48, v35
    v_and_b32 v48, 0xffff0000, v24
    v_fmac_f32 v51, v48, v36
    v_lshlrev_b32 v48, 16, v25
    v_fmac_f32 v51, v48, v37
    v_and_b32 v48, 0xffff0000, v25
    v_fmac_f32 v51, v48, v38
    v_lshlrev_b32 v48, 16, v26
    v_fmac_f32 v51, v48, v39
    v_and_b32 v48, 0xffff0000, v26
    v_fmac_f32 v51, v48, v40
    v_lshlrev_b32 v48, 16, v27
    v_fmac_f32 v51, v48, v41
    v_and_b32 v48, 0xffff0000, v27
    v_fmac_f32 v51, v48, v42
    v_lshlrev_b32 v48, 16, v28
    v_fmac_f32 v51, v48, v43
    v_and_b32 v48, 0xffff0000, v28
    v_fmac_f32 v51, v48, v44
    v_cvt_pk_bf16_f32 v48, v50, v51
    v_lshlrev_b32 v50, 16, v48
    v_and_b32 v51, 0xffff0000, v48
    v_add_f32 v50, v50, v45
    v_add_f32 v51, v51, v45
    v_cvt_pk_bf16_f32 v48, v50, v51
    v_lshlrev_b32 v12, 16, v48
    v_and_b32 v13, 0xffff0000, v48
    s_waitcnt vmcnt(0)
    v_readfirstlane_b32 s57, v56
    s_nop 3
    s_lshr_b32 s57, s57, s56
    s_and_b32 s57, s57, 1
    s_lshl_b32 s57, s57, 10
    s_xor_b32 s69, s69, s57
    s_mov_b32 s44, s22
    s_and_b32 s45, s23, 0xffff
    s_mov_b32 s46, 32768
    s_mov_b32 s47, 0x00020000
    v_lshlrev_b32 v14, 3, v0
    v_add_u32 v14, 147456, v14
    v_lshlrev_b32 v15, 4, v0
    v_mov_b32 v53, 1
    v_mov_b32 v55, 1
    s_barrier
    ds_read_b64 v[16:17], v14 offset:0
    ds_read_b64 v[18:19], v14 offset:512
    ds_read_b64 v[20:21], v14 offset:1024
    ds_read_b64 v[22:23], v14 offset:1536
    ds_read_b64 v[24:25], v14 offset:2048
    ds_read_b64 v[26:27], v14 offset:2560
    ds_read_b64 v[28:29], v14 offset:3072
    ds_read_b64 v[30:31], v14 offset:3584
    ds_read_b64 v[32:33], v14 offset:4096
    ds_read_b64 v[34:35], v14 offset:4608
    ds_read_b64 v[36:37], v14 offset:5120
    ds_read_b64 v[38:39], v14 offset:5632
    ds_read_b64 v[40:41], v14 offset:6144
    ds_read_b64 v[42:43], v14 offset:6656
    ds_read_b64 v[44:45], v14 offset:7168
    ds_read_b64 v[46:47], v14 offset:7680
    s_waitcnt lgkmcnt(0)
    v_add_f32 v16, v16, v18
    v_add_f32 v17, v17, v19
    v_add_f32 v16, v16, v20
    v_add_f32 v17, v17, v21
    v_add_f32 v16, v16, v22
    v_add_f32 v17, v17, v23
    v_add_f32 v16, v16, v24
    v_add_f32 v17, v17, v25
    v_add_f32 v16, v16, v26
    v_add_f32 v17, v17, v27
    v_add_f32 v16, v16, v28
    v_add_f32 v17, v17, v29
    v_add_f32 v16, v16, v30
    v_add_f32 v17, v17, v31
    v_add_f32 v16, v16, v32
    v_add_f32 v17, v17, v33
    v_add_f32 v16, v16, v34
    v_add_f32 v17, v17, v35
    v_add_f32 v16, v16, v36
    v_add_f32 v17, v17, v37
    v_add_f32 v16, v16, v38
    v_add_f32 v17, v17, v39
    v_add_f32 v16, v16, v40
    v_add_f32 v17, v17, v41
    v_add_f32 v16, v16, v42
    v_add_f32 v17, v17, v43
    v_add_f32 v16, v16, v44
    v_add_f32 v17, v17, v45
    v_add_f32 v16, v16, v46
    v_add_f32 v17, v17, v47
    v_mov_b32 v52, v16
    v_mov_b32 v54, v17
    buffer_atomic_swap_x2 v[52:53], v15, s[40:43], s69 offen sc0
    buffer_atomic_swap_x2 v[54:55], v15, s[40:43], s69 offen offset:8 sc0
    v_lshlrev_b32 v14, 2, v0
    s_lshl_b32 s55, s50, 1
    s_waitcnt vmcnt(0)
    v_add_f32 v16, v16, v52
    v_add_f32 v17, v17, v54
    v_cvt_pk_bf16_f32 v18, v16, v17
    v_lshlrev_b32 v16, 16, v18
    v_and_b32 v17, 0xffff0000, v18
    v_add_f32 v16, v16, v1
    v_add_f32 v17, v17, v1
    v_cvt_pk_bf16_f32 v18, v16, v17
    v_lshlrev_b32 v16, 16, v18
    v_and_b32 v17, 0xffff0000, v18
    v_add_f32 v16, v16, v12
    v_add_f32 v17, v17, v13
    v_cvt_pk_bf16_f32 v18, v16, v17
    v_lshlrev_b32 v16, 16, v18
    v_and_b32 v17, 0xffff0000, v18
    v_mul_f32 v16, 0xbfb8aa3b, v16
    v_mul_f32 v17, 0xbfb8aa3b, v17
    v_exp_f32 v16, v16
    v_exp_f32 v17, v17
    s_nop 0
    v_add_f32 v16, 1.0, v16
    v_add_f32 v17, 1.0, v17
    v_rcp_f32 v16, v16
    v_rcp_f32 v17, v17
    s_nop 0
    v_cvt_pk_bf16_f32 v18, v16, v17
    v_cmp_eq_u32 vcc, 1, v53
    s_and_saveexec_b64 s[60:61], vcc
    s_cbranch_execz L_x1
    buffer_store_short v18, v14, s[44:47], s55 offen
L_x1:
    s_mov_b64 exec, s[60:61]
    v_cmp_eq_u32 vcc, 1, v55
    s_and_saveexec_b64 s[60:61], vcc
    s_cbranch_execz L_x2
    buffer_store_short_d16_hi v18, v14, s[44:47], s55 offen offset:2
L_x2:
    s_mov_b64 exec, s[60:61]
L_end:
    s_endpgm
L_text_end:
.section .rodata,"a"
.p2align 6
.amdhsa_kernel standalone__deep_cross_wide_deep__recsys_kernel
  .amdhsa_next_free_vgpr 256
  .amdhsa_next_free_sgpr 102
  .amdhsa_accum_offset 256
  .amdhsa_group_segment_fixed_size 0
  .amdhsa_kernarg_size 96
  .amdhsa_user_sgpr_count 2
  .amdhsa_user_sgpr_kernarg_segment_ptr 1
  .amdhsa_system_sgpr_workgroup_id_x 1
.end_amdhsa_kernel
```
